```python
import torch

def _softmax(x, axis=-1):
    return torch.softmax(x, dim=axis)
def _gelu(x):
    return torch.nn.functional.gelu(x, approximate="tanh")
def _silu(x):
    return torch.nn.functional.silu(x)
def _sigmoid(x):
    return torch.sigmoid(x)
def _layernorm(x, axis=-1, eps=1e-5):
    m = x.mean(dim=axis, keepdim=True)
    v = x.var(dim=axis, keepdim=True, unbiased=False)
    return (x - m) / torch.sqrt(v + eps)
def _scatter_add(tgt, idx, src, axis=0):
    return tgt.clone().index_add_(axis, idx, src)
def _segment_sum(src, seg, n):
    out = torch.zeros((n,) + src.shape[1:], dtype=src.dtype)
    return out.index_add_(0, seg, src)
def _pad(x, pw):
    flat = tuple(v for pair in reversed(pw) for v in pair)
    return torch.nn.functional.pad(x, flat)

kernel_name = 'recurrent_scan__sliding_local_dilated__glu_gated_swiglu__prompt'

def setup_inputs():

    _w = (lambda a: (lambda t: t.to(torch.bfloat16) if t.is_floating_point() else t)(torch.as_tensor(a)))
    def _A_setup():
        B, S, D = 1, 2048, 1024
        return {
            "x": _w((lambda *s: torch.randn(*s, dtype=torch.bfloat16) * 0.05)(B, S, D)),
            "wqkv": _w((lambda *s: torch.randn(*s, dtype=torch.bfloat16) * 0.2)(D, 3 * D)),
            "wo": _w((lambda *s: torch.randn(*s, dtype=torch.bfloat16) * 0.2)(D, D)),
        }
    _A_in = _A_setup()

    def _B_setup():
        B, S, D, F = 1, 2048, 1024, 3584
        return {
            "x": _w((lambda *s: torch.randn(*s, dtype=torch.bfloat16) * 0.05)(B, S, D)),
            "w1": _w((lambda *s: torch.randn(*s, dtype=torch.bfloat16) * 0.1)(D, F) * (2.0 / D) ** 0.5),
            "w3": _w((lambda *s: torch.randn(*s, dtype=torch.bfloat16) * 0.1)(D, F) * (2.0 / D) ** 0.5),
            "w2": _w((lambda *s: torch.randn(*s, dtype=torch.bfloat16) * 0.1)(F, D) * (2.0 / F) ** 0.5),
        }
    _B_in = _B_setup()

    return {
        "A_x": _A_in["x"],
        "A_wqkv": _A_in["wqkv"],
        "A_wo": _A_in["wo"],
        "B_x": _B_in["x"],
        "B_w1": _B_in["w1"],
        "B_w3": _B_in["w3"],
        "B_w2": _B_in["w2"],
    }

def reference(A_x, A_wqkv, A_wo, B_x, B_w1, B_w3, B_w2):
    def _A_ref(x, wqkv, wo):
        B, S, D = x.shape
        H = 32; Dh = D // H
        W, dil = 8, 2
        qkv = (lambda x, *d: x.permute(*d))((x @ wqkv).reshape(B, S, 3, H, Dh), 2, 0, 3, 1, 4)
        q, k, v = qkv[0], qkv[1], qkv[2]
        scale = Dh ** -0.5
        pos = torch.arange(S)
        off = torch.arange(W) * dil
        idx = pos[:, None] - off[None, :]
        mask = idx >= 0
        idx_c = torch.where(mask, idx, 0).reshape(-1)
        kg = k[:, :, idx_c, :].reshape(B, H, S, W, Dh)
        vg = v[:, :, idx_c, :].reshape(B, H, S, W, Dh)
        logits = torch.einsum("bhsd,bhswd->bhsw", q, kg) * scale
        logits = torch.where(mask[None, None, :, :], logits, -1e9)
        attn = _softmax(logits, axis=-1)
        o = torch.einsum("bhsw,bhswd->bhsd", attn, vg)
        return (lambda x, *d: x.permute(*d))(o, 0, 2, 1, 3).reshape(B, S, D) @ wo

    def _B_ref(x, w1, w3, w2):
        gate = torch.einsum("bsd,df->bsf", x, w1)
        up = torch.einsum("bsd,df->bsf", x, w3)
        h = _silu(gate) * up
        out = torch.einsum("bsf,fd->bsd", h, w2)
        return out

    x = A_x
    xn = _layernorm(x, axis=-1)
    s = _A_ref(xn, A_wqkv, A_wo)
    g = _silu(_B_ref(xn, B_w1, B_w3, B_w2))
    return x + s * g
```

```asm
; @launch kernel=ln_kernel grid=(512,1,1) block=(256,1,1) lds=0
; @launch kernel=gemm1_kernel grid=(256,1,1) block=(512,1,1) lds=163840
; @launch kernel=att_kernel grid=(1024,1,1) block=(256,1,1) lds=0
; @launch kernel=gemm2_kernel grid=(256,1,1) block=(512,1,1) lds=147456
.amdgcn_target "amdgcn-amd-amdhsa--gfx950"
.text
.globl ln_kernel
.p2align 8
.type ln_kernel,@function
ln_kernel:
    s_cmp_ge_u32 s2, 512
    s_cbranch_scc1 L_ln_end_1
    s_load_dwordx2 s[4:5], s[0:1], 0
    s_load_dwordx2 s[6:7], s[0:1], 72
    v_lshrrev_b32 v1, 6, v0
    v_and_b32 v2, 63, v0
    s_lshl_b32 s3, s2, 2
    v_add_u32 v1, s3, v1
    v_lshlrev_b32 v3, 11, v1
    v_lshl_add_u32 v3, v2, 5, v3
    s_waitcnt lgkmcnt(0)
    global_load_dwordx4 v[4:7], v3, s[4:5]
    global_load_dwordx4 v[8:11], v3, s[4:5] offset:16
    s_add_u32 s6, s6, 0
    s_addc_u32 s7, s7, 0
    s_waitcnt vmcnt(0)
    v_lshlrev_b32 v16, 16, v4
    v_and_b32 v17, 0xffff0000, v4
    v_lshlrev_b32 v18, 16, v5
    v_and_b32 v19, 0xffff0000, v5
    v_lshlrev_b32 v20, 16, v6
    v_and_b32 v21, 0xffff0000, v6
    v_lshlrev_b32 v22, 16, v7
    v_and_b32 v23, 0xffff0000, v7
    v_lshlrev_b32 v24, 16, v8
    v_and_b32 v25, 0xffff0000, v8
    v_lshlrev_b32 v26, 16, v9
    v_and_b32 v27, 0xffff0000, v9
    v_lshlrev_b32 v28, 16, v10
    v_and_b32 v29, 0xffff0000, v10
    v_lshlrev_b32 v30, 16, v11
    v_and_b32 v31, 0xffff0000, v11
    v_add_f32 v32, v16, v17
    v_add_f32 v32, v32, v18
    v_add_f32 v32, v32, v19
    v_add_f32 v32, v32, v20
    v_add_f32 v32, v32, v21
    v_add_f32 v32, v32, v22
    v_add_f32 v32, v32, v23
    v_add_f32 v32, v32, v24
    v_add_f32 v32, v32, v25
    v_add_f32 v32, v32, v26
    v_add_f32 v32, v32, v27
    v_add_f32 v32, v32, v28
    v_add_f32 v32, v32, v29
    v_add_f32 v32, v32, v30
    v_add_f32 v32, v32, v31
    s_nop 1
    v_add_f32 v33, v32, v32 row_shr:1 bound_ctrl:0
    v_mov_b32 v32, v33
    s_nop 1
    v_add_f32 v33, v32, v32 row_shr:2 bound_ctrl:0
    v_mov_b32 v32, v33
    s_nop 1
    v_add_f32 v33, v32, v32 row_shr:4 bound_ctrl:0
    v_mov_b32 v32, v33
    s_nop 1
    v_add_f32 v33, v32, v32 row_shr:8 bound_ctrl:0
    v_mov_b32 v32, v33
    s_nop 1
    v_readlane_b32 s8, v32, 15
    v_readlane_b32 s9, v32, 31
    v_readlane_b32 s10, v32, 47
    v_readlane_b32 s11, v32, 63
    s_nop 1
    v_mov_b32 v32, s8
    v_add_f32 v32, s9, v32
    v_add_f32 v32, s10, v32
    v_add_f32 v32, s11, v32
    v_mul_f32 v32, 0x3a800000, v32
    v_sub_f32 v34, v16, v32
    v_mul_f32 v35, v34, v34
    v_sub_f32 v34, v17, v32
    v_fmac_f32 v35, v34, v34
    v_sub_f32 v34, v18, v32
    v_fmac_f32 v35, v34, v34
    v_sub_f32 v34, v19, v32
    v_fmac_f32 v35, v34, v34
    v_sub_f32 v34, v20, v32
    v_fmac_f32 v35, v34, v34
    v_sub_f32 v34, v21, v32
    v_fmac_f32 v35, v34, v34
    v_sub_f32 v34, v22, v32
    v_fmac_f32 v35, v34, v34
    v_sub_f32 v34, v23, v32
    v_fmac_f32 v35, v34, v34
    v_sub_f32 v34, v24, v32
    v_fmac_f32 v35, v34, v34
    v_sub_f32 v34, v25, v32
    v_fmac_f32 v35, v34, v34
    v_sub_f32 v34, v26, v32
    v_fmac_f32 v35, v34, v34
    v_sub_f32 v34, v27, v32
    v_fmac_f32 v35, v34, v34
    v_sub_f32 v34, v28, v32
    v_fmac_f32 v35, v34, v34
    v_sub_f32 v34, v29, v32
    v_fmac_f32 v35, v34, v34
    v_sub_f32 v34, v30, v32
    v_fmac_f32 v35, v34, v34
    v_sub_f32 v34, v31, v32
    v_fmac_f32 v35, v34, v34
    s_nop 1
    v_add_f32 v33, v35, v35 row_shr:1 bound_ctrl:0
    v_mov_b32 v35, v33
    s_nop 1
    v_add_f32 v33, v35, v35 row_shr:2 bound_ctrl:0
    v_mov_b32 v35, v33
    s_nop 1
    v_add_f32 v33, v35, v35 row_shr:4 bound_ctrl:0
    v_mov_b32 v35, v33
    s_nop 1
    v_add_f32 v33, v35, v35 row_shr:8 bound_ctrl:0
    v_mov_b32 v35, v33
    s_nop 1
    v_readlane_b32 s8, v35, 15
    v_readlane_b32 s9, v35, 31
    v_readlane_b32 s10, v35, 47
    v_readlane_b32 s11, v35, 63
    s_nop 1
    v_mov_b32 v35, s8
    v_add_f32 v35, s9, v35
    v_add_f32 v35, s10, v35
    v_add_f32 v35, s11, v35
    v_mul_f32 v35, 0x3a800000, v35
    v_cvt_pk_bf16_f32 v32, v32, v32
    v_lshlrev_b32 v32, 16, v32
    v_cvt_pk_bf16_f32 v35, v35, v35
    v_lshlrev_b32 v35, 16, v35
    v_add_f32 v35, 0x3727c5ac, v35
    v_cvt_pk_bf16_f32 v35, v35, v35
    v_lshlrev_b32 v35, 16, v35
    v_sqrt_f32 v36, v35
    s_nop 0
    v_cvt_pk_bf16_f32 v36, v36, v36
    v_lshlrev_b32 v36, 16, v36
    v_rcp_f32 v37, v36
    s_nop 0
    v_sub_f32 v16, v16, v32
    v_cvt_pk_bf16_f32 v16, v16, v16
    v_lshlrev_b32 v16, 16, v16
    v_mul_f32 v34, v16, v37
    v_fma_f32 v38, -v34, v36, v16
    v_fma_f32 v16, v38, v37, v34
    v_sub_f32 v17, v17, v32
    v_cvt_pk_bf16_f32 v17, v17, v17
    v_lshlrev_b32 v17, 16, v17
    v_mul_f32 v34, v17, v37
    v_fma_f32 v38, -v34, v36, v17
    v_fma_f32 v17, v38, v37, v34
    v_sub_f32 v18, v18, v32
    v_cvt_pk_bf16_f32 v18, v18, v18
    v_lshlrev_b32 v18, 16, v18
    v_mul_f32 v34, v18, v37
    v_fma_f32 v38, -v34, v36, v18
    v_fma_f32 v18, v38, v37, v34
    v_sub_f32 v19, v19, v32
    v_cvt_pk_bf16_f32 v19, v19, v19
    v_lshlrev_b32 v19, 16, v19
    v_mul_f32 v34, v19, v37
    v_fma_f32 v38, -v34, v36, v19
    v_fma_f32 v19, v38, v37, v34
    v_sub_f32 v20, v20, v32
    v_cvt_pk_bf16_f32 v20, v20, v20
    v_lshlrev_b32 v20, 16, v20
    v_mul_f32 v34, v20, v37
    v_fma_f32 v38, -v34, v36, v20
    v_fma_f32 v20, v38, v37, v34
    v_sub_f32 v21, v21, v32
    v_cvt_pk_bf16_f32 v21, v21, v21
    v_lshlrev_b32 v21, 16, v21
    v_mul_f32 v34, v21, v37
    v_fma_f32 v38, -v34, v36, v21
    v_fma_f32 v21, v38, v37, v34
    v_sub_f32 v22, v22, v32
    v_cvt_pk_bf16_f32 v22, v22, v22
    v_lshlrev_b32 v22, 16, v22
    v_mul_f32 v34, v22, v37
    v_fma_f32 v38, -v34, v36, v22
    v_fma_f32 v22, v38, v37, v34
    v_sub_f32 v23, v23, v32
    v_cvt_pk_bf16_f32 v23, v23, v23
    v_lshlrev_b32 v23, 16, v23
    v_mul_f32 v34, v23, v37
    v_fma_f32 v38, -v34, v36, v23
    v_fma_f32 v23, v38, v37, v34
    v_sub_f32 v24, v24, v32
    v_cvt_pk_bf16_f32 v24, v24, v24
    v_lshlrev_b32 v24, 16, v24
    v_mul_f32 v34, v24, v37
    v_fma_f32 v38, -v34, v36, v24
    v_fma_f32 v24, v38, v37, v34
    v_sub_f32 v25, v25, v32
    v_cvt_pk_bf16_f32 v25, v25, v25
    v_lshlrev_b32 v25, 16, v25
    v_mul_f32 v34, v25, v37
    v_fma_f32 v38, -v34, v36, v25
    v_fma_f32 v25, v38, v37, v34
    v_sub_f32 v26, v26, v32
    v_cvt_pk_bf16_f32 v26, v26, v26
    v_lshlrev_b32 v26, 16, v26
    v_mul_f32 v34, v26, v37
    v_fma_f32 v38, -v34, v36, v26
    v_fma_f32 v26, v38, v37, v34
    v_sub_f32 v27, v27, v32
    v_cvt_pk_bf16_f32 v27, v27, v27
    v_lshlrev_b32 v27, 16, v27
    v_mul_f32 v34, v27, v37
    v_fma_f32 v38, -v34, v36, v27
    v_fma_f32 v27, v38, v37, v34
    v_sub_f32 v28, v28, v32
    v_cvt_pk_bf16_f32 v28, v28, v28
    v_lshlrev_b32 v28, 16, v28
    v_mul_f32 v34, v28, v37
    v_fma_f32 v38, -v34, v36, v28
    v_fma_f32 v28, v38, v37, v34
    v_sub_f32 v29, v29, v32
    v_cvt_pk_bf16_f32 v29, v29, v29
    v_lshlrev_b32 v29, 16, v29
    v_mul_f32 v34, v29, v37
    v_fma_f32 v38, -v34, v36, v29
    v_fma_f32 v29, v38, v37, v34
    v_sub_f32 v30, v30, v32
    v_cvt_pk_bf16_f32 v30, v30, v30
    v_lshlrev_b32 v30, 16, v30
    v_mul_f32 v34, v30, v37
    v_fma_f32 v38, -v34, v36, v30
    v_fma_f32 v30, v38, v37, v34
    v_sub_f32 v31, v31, v32
    v_cvt_pk_bf16_f32 v31, v31, v31
    v_lshlrev_b32 v31, 16, v31
    v_mul_f32 v34, v31, v37
    v_fma_f32 v38, -v34, v36, v31
    v_fma_f32 v31, v38, v37, v34
    v_cvt_pk_bf16_f32 v4, v16, v17
    v_cvt_pk_bf16_f32 v5, v18, v19
    v_cvt_pk_bf16_f32 v6, v20, v21
    v_cvt_pk_bf16_f32 v7, v22, v23
    v_cvt_pk_bf16_f32 v8, v24, v25
    v_cvt_pk_bf16_f32 v9, v26, v27
    v_cvt_pk_bf16_f32 v10, v28, v29
    v_cvt_pk_bf16_f32 v11, v30, v31
    global_store_dwordx4 v3, v[4:7], s[6:7]
    global_store_dwordx4 v3, v[8:11], s[6:7] offset:16
L_ln_end_1:
    s_endpgm
.globl gemm1_kernel
.p2align 8
.type gemm1_kernel,@function
gemm1_kernel:
    s_cmp_ge_u32 s2, 256
    s_cbranch_scc1 L_g1_early_3
    s_load_dwordx2 s[4:5], s[0:1], 8
    s_load_dwordx2 s[6:7], s[0:1], 32
    s_load_dwordx2 s[8:9], s[0:1], 40
    s_load_dwordx2 s[10:11], s[0:1], 72
    s_lshr_b32 s38, s2, 5
    s_and_b32 s39, s2, 31
    v_lshrrev_b32 v1, 6, v0
    v_and_b32 v2, 63, v0
    s_nop 0
    v_readfirstlane_b32 s35, v1
    s_and_b32 s36, s35, 3
    s_lshr_b32 s37, s35, 2

    v_lshrrev_b32 v3, 4, v2
    v_and_b32 v4, 15, v2
    v_bfe_u32 v5, v2, 2, 2
    v_and_b32 v6, 3, v2
    v_lshrrev_b32 v7, 2, v2
    v_lshrrev_b32 v8, 1, v3
    v_xor_b32 v9, v3, v8
    v_and_b32 v9, 1, v9
    v_lshl_or_b32 v8, v9, 1, v8
    v_xor_b32 v8, v6, v8
    v_lshlrev_b32 v8, 4, v8
    v_lshl_add_u32 v83, v7, 11, v8
    s_lshr_b32 s44, s35, 1
    s_and_b32 s44, s44, 1
    s_lshl_b32 s44, s44, 2
    v_or_b32 v8, s44, v3
    v_lshrrev_b32 v9, 1, v4
    v_xor_b32 v9, v9, v8
    v_and_b32 v10, 1, v4
    v_lshl_or_b32 v9, v9, 1, v10
    v_cmp_gt_u32 s[26:27], 12, v9
    v_cmp_gt_u32 s[28:29], 14, v9
    v_lshlrev_b32 v9, 4, v9
    v_mul_u32_u24 v84, 6144, v3
    v_add_u32 v84, v84, v9
    v_mul_u32_u24 v85, 7168, v3
    v_add_u32 v85, v85, v9
    v_lshrrev_b32 v8, 1, v5
    v_xor_b32 v9, v5, v8
    v_and_b32 v9, 1, v9
    v_lshl_or_b32 v8, v9, 1, v8
    v_xor_b32 v8, v3, v8
    v_lshlrev_b32 v8, 4, v8
    s_lshl_b32 s44, s36, 12
    v_lshl_add_u32 v82, v4, 6, v8
    v_add_u32 v82, s44, v82
    v_lshl_add_u32 v8, v3, 3, v5
    v_lshlrev_b32 v8, 8, v8
    v_lshl_add_u32 v8, v6, 3, v8
    v_and_b32 v9, 1, v3
    v_lshl_or_b32 v9, v9, 2, v5
    s_cmp_eq_u32 s37, 0
    s_cselect_b32 s44, 0, 2
    s_mov_b32 s46, 24576
    s_cselect_b32 s45, 16384, s46
    v_xor_b32 v10, s44, v9
    v_lshlrev_b32 v10, 5, v10
    v_add3_u32 v72, v10, v8, s45
    s_cmp_eq_u32 s37, 0
    s_cselect_b32 s44, 1, 3
    s_mov_b32 s46, 24576
    s_cselect_b32 s45, 16384, s46
    v_xor_b32 v10, s44, v9
    v_lshlrev_b32 v10, 5, v10
    v_add3_u32 v73, v10, v8, s45
    s_cmp_eq_u32 s37, 0
    s_cselect_b32 s44, 2, 4
    s_mov_b32 s46, 24576
    s_cselect_b32 s45, 16384, s46
    v_xor_b32 v10, s44, v9
    v_lshlrev_b32 v10, 5, v10
    v_add3_u32 v74, v10, v8, s45
    s_cmp_eq_u32 s37, 0
    s_cselect_b32 s44, 3, 5
    s_mov_b32 s46, 24576
    s_cselect_b32 s45, 16384, s46
    v_xor_b32 v10, s44, v9
    v_lshlrev_b32 v10, 5, v10
    v_add3_u32 v75, v10, v8, s45
    s_cmp_eq_u32 s37, 0
    s_cselect_b32 s44, 4, 6
    s_mov_b32 s46, 24576
    s_cselect_b32 s45, 16384, s46
    v_xor_b32 v10, s44, v9
    v_lshlrev_b32 v10, 5, v10
    v_add3_u32 v76, v10, v8, s45
    s_cmp_eq_u32 s37, 0
    s_cselect_b32 s44, 5, 2
    s_mov_b32 s46, 32768
    s_cselect_b32 s45, 16384, s46
    v_xor_b32 v10, s44, v9
    v_lshlrev_b32 v10, 5, v10
    v_add3_u32 v77, v10, v8, s45
    s_cmp_eq_u32 s37, 0
    s_cselect_b32 s44, 0, 3
    s_mov_b32 s46, 32768
    s_cselect_b32 s45, 24576, s46
    v_xor_b32 v10, s44, v9
    v_lshlrev_b32 v10, 5, v10
    v_add3_u32 v78, v10, v8, s45
    s_cmp_eq_u32 s37, 0
    s_cselect_b32 s44, 1, 4
    s_mov_b32 s46, 32768
    s_cselect_b32 s45, 24576, s46
    v_xor_b32 v10, s44, v9
    v_lshlrev_b32 v10, 5, v10
    v_add3_u32 v79, v10, v8, s45
    s_cmp_eq_u32 s37, 0
    s_cselect_b32 s44, 0, 5
    s_mov_b32 s46, 32768
    s_cselect_b32 s45, 32768, s46
    v_xor_b32 v10, s44, v9
    v_lshlrev_b32 v10, 5, v10
    v_add3_u32 v80, v10, v8, s45
    s_cmp_eq_u32 s37, 0
    s_cselect_b32 s44, 1, 6
    s_mov_b32 s46, 32768
    s_cselect_b32 s45, 32768, s46
    v_xor_b32 v10, s44, v9
    v_lshlrev_b32 v10, 5, v10
    v_add3_u32 v81, v10, v8, s45
    s_waitcnt lgkmcnt(0)
    s_lshl_b32 s44, s38, 19
    s_lshl_b32 s45, s35, 16
    s_add_u32 s44, s44, s45
    s_add_u32 s44, s44, 0
    s_add_u32 s16, s10, s44
    s_addc_u32 s17, s11, 0
    s_add_u32 s18, s16, 32768
    s_addc_u32 s19, s17, 0
    s_mul_i32 s44, s35, 24576
    s_mul_i32 s45, s39, 192
    s_add_u32 s44, s44, s45
    s_add_u32 s20, s4, s44
    s_addc_u32 s21, s5, 0
    s_mul_i32 s44, s35, 28672
    s_mul_i32 s45, s39, 224
    s_add_u32 s44, s44, s45
    s_add_u32 s22, s6, s44
    s_addc_u32 s23, s7, 0
    s_add_u32 s24, s8, s44
    s_addc_u32 s25, s9, 0
    s_lshl_b32 s30, s35, 11
    s_add_u32 s31, s30, 1024
    s_lshl_b32 s44, s35, 10
    s_add_u32 s32, s44, 16384
    s_add_u32 s33, s44, 24576
    s_add_u32 s34, s44, 32768
    s_add_u32 m0, s30, 0
    s_nop 0
    global_load_lds_dwordx4 v83, s[16:17]
    s_add_u32 m0, s31, 0
    s_nop 0
    global_load_lds_dwordx4 v83, s[18:19]
    v_add_u32 v83, 64, v83
    s_add_u32 m0, s32, 0
    s_mov_b64 exec, s[26:27]
    global_load_lds_dwordx4 v84, s[20:21]
    s_mov_b64 exec, -1
    v_add_u32 v84, 196608, v84
    s_add_u32 m0, s33, 0
    s_mov_b64 exec, s[28:29]
    global_load_lds_dwordx4 v85, s[22:23]
    s_mov_b64 exec, -1
    s_add_u32 m0, s34, 0
    s_mov_b64 exec, s[28:29]
    global_load_lds_dwordx4 v85, s[24:25]
    s_mov_b64 exec, -1
    v_add_u32 v85, 229376, v85
    s_add_u32 m0, s30, 40960
    s_nop 0
    global_load_lds_dwordx4 v83, s[16:17]
    s_add_u32 m0, s31, 40960
    s_nop 0
    global_load_lds_dwordx4 v83, s[18:19]
    v_add_u32 v83, 64, v83
    s_add_u32 m0, s32, 40960
    s_mov_b64 exec, s[26:27]
    global_load_lds_dwordx4 v84, s[20:21]
    s_mov_b64 exec, -1
    v_add_u32 v84, 196608, v84
    s_add_u32 m0, s33, 40960
    s_mov_b64 exec, s[28:29]
    global_load_lds_dwordx4 v85, s[22:23]
    s_mov_b64 exec, -1
    s_add_u32 m0, s34, 40960
    s_mov_b64 exec, s[28:29]
    global_load_lds_dwordx4 v85, s[24:25]
    s_mov_b64 exec, -1
    v_add_u32 v85, 229376, v85
    s_add_u32 m0, s30, 81920
    s_nop 0
    global_load_lds_dwordx4 v83, s[16:17]
    s_add_u32 m0, s31, 81920
    s_nop 0
    global_load_lds_dwordx4 v83, s[18:19]
    v_add_u32 v83, 64, v83
    s_add_u32 m0, s32, 81920
    s_mov_b64 exec, s[26:27]
    global_load_lds_dwordx4 v84, s[20:21]
    s_mov_b64 exec, -1
    v_add_u32 v84, 196608, v84
    s_add_u32 m0, s33, 81920
    s_mov_b64 exec, s[28:29]
    global_load_lds_dwordx4 v85, s[22:23]
    s_mov_b64 exec, -1
    s_add_u32 m0, s34, 81920
    s_mov_b64 exec, s[28:29]
    global_load_lds_dwordx4 v85, s[24:25]
    s_mov_b64 exec, -1
    v_add_u32 v85, 229376, v85
    v_mov_b32 v96, 0
    v_mov_b32 v97, 0
    v_mov_b32 v98, 0
    v_mov_b32 v99, 0
    v_mov_b32 v100, 0
    v_mov_b32 v101, 0
    v_mov_b32 v102, 0
    v_mov_b32 v103, 0
    v_mov_b32 v104, 0
    v_mov_b32 v105, 0
    v_mov_b32 v106, 0
    v_mov_b32 v107, 0
    v_mov_b32 v108, 0
    v_mov_b32 v109, 0
    v_mov_b32 v110, 0
    v_mov_b32 v111, 0
    v_mov_b32 v112, 0
    v_mov_b32 v113, 0
    v_mov_b32 v114, 0
    v_mov_b32 v115, 0
    v_mov_b32 v116, 0
    v_mov_b32 v117, 0
    v_mov_b32 v118, 0
    v_mov_b32 v119, 0
    v_mov_b32 v120, 0
    v_mov_b32 v121, 0
    v_mov_b32 v122, 0
    v_mov_b32 v123, 0
    v_mov_b32 v124, 0
    v_mov_b32 v125, 0
    v_mov_b32 v126, 0
    v_mov_b32 v127, 0
    v_mov_b32 v128, 0
    v_mov_b32 v129, 0
    v_mov_b32 v130, 0
    v_mov_b32 v131, 0
    v_mov_b32 v132, 0
    v_mov_b32 v133, 0
    v_mov_b32 v134, 0
    v_mov_b32 v135, 0
    v_mov_b32 v136, 0
    v_mov_b32 v137, 0
    v_mov_b32 v138, 0
    v_mov_b32 v139, 0
    v_mov_b32 v140, 0
    v_mov_b32 v141, 0
    v_mov_b32 v142, 0
    v_mov_b32 v143, 0
    v_mov_b32 v144, 0
    v_mov_b32 v145, 0
    v_mov_b32 v146, 0
    v_mov_b32 v147, 0
    v_mov_b32 v148, 0
    v_mov_b32 v149, 0
    v_mov_b32 v150, 0
    v_mov_b32 v151, 0
    v_mov_b32 v152, 0
    v_mov_b32 v153, 0
    v_mov_b32 v154, 0
    v_mov_b32 v155, 0
    v_mov_b32 v156, 0
    v_mov_b32 v157, 0
    v_mov_b32 v158, 0
    v_mov_b32 v159, 0
    v_mov_b32 v160, 0
    v_mov_b32 v161, 0
    v_mov_b32 v162, 0
    v_mov_b32 v163, 0
    v_mov_b32 v164, 0
    v_mov_b32 v165, 0
    v_mov_b32 v166, 0
    v_mov_b32 v167, 0
    v_mov_b32 v168, 0
    v_mov_b32 v169, 0
    v_mov_b32 v170, 0
    v_mov_b32 v171, 0
    v_mov_b32 v172, 0
    v_mov_b32 v173, 0
    v_mov_b32 v174, 0
    v_mov_b32 v175, 0
    v_mov_b32 v176, 0
    v_mov_b32 v177, 0
    v_mov_b32 v178, 0
    v_mov_b32 v179, 0
    v_mov_b32 v180, 0
    v_mov_b32 v181, 0
    v_mov_b32 v182, 0
    v_mov_b32 v183, 0
    v_mov_b32 v184, 0
    v_mov_b32 v185, 0
    v_mov_b32 v186, 0
    v_mov_b32 v187, 0
    v_mov_b32 v188, 0
    v_mov_b32 v189, 0
    v_mov_b32 v190, 0
    v_mov_b32 v191, 0
    v_mov_b32 v192, 0
    v_mov_b32 v193, 0
    v_mov_b32 v194, 0
    v_mov_b32 v195, 0
    v_mov_b32 v196, 0
    v_mov_b32 v197, 0
    v_mov_b32 v198, 0
    v_mov_b32 v199, 0
    v_mov_b32 v200, 0
    v_mov_b32 v201, 0
    v_mov_b32 v202, 0
    v_mov_b32 v203, 0
    v_mov_b32 v204, 0
    v_mov_b32 v205, 0
    v_mov_b32 v206, 0
    v_mov_b32 v207, 0
    v_mov_b32 v208, 0
    v_mov_b32 v209, 0
    v_mov_b32 v210, 0
    v_mov_b32 v211, 0
    v_mov_b32 v212, 0
    v_mov_b32 v213, 0
    v_mov_b32 v214, 0
    v_mov_b32 v215, 0
    v_mov_b32 v216, 0
    v_mov_b32 v217, 0
    v_mov_b32 v218, 0
    v_mov_b32 v219, 0
    v_mov_b32 v220, 0
    v_mov_b32 v221, 0
    v_mov_b32 v222, 0
    v_mov_b32 v223, 0
    v_mov_b32 v224, 0
    v_mov_b32 v225, 0
    v_mov_b32 v226, 0
    v_mov_b32 v227, 0
    v_mov_b32 v228, 0
    v_mov_b32 v229, 0
    v_mov_b32 v230, 0
    v_mov_b32 v231, 0
    v_mov_b32 v232, 0
    v_mov_b32 v233, 0
    v_mov_b32 v234, 0
    v_mov_b32 v235, 0
    v_mov_b32 v236, 0
    v_mov_b32 v237, 0
    v_mov_b32 v238, 0
    v_mov_b32 v239, 0
    v_mov_b32 v240, 0
    v_mov_b32 v241, 0
    v_mov_b32 v242, 0
    v_mov_b32 v243, 0
    v_mov_b32 v244, 0
    v_mov_b32 v245, 0
    v_mov_b32 v246, 0
    v_mov_b32 v247, 0
    v_mov_b32 v248, 0
    v_mov_b32 v249, 0
    v_mov_b32 v250, 0
    v_mov_b32 v251, 0
    v_mov_b32 v252, 0
    v_mov_b32 v253, 0
    v_mov_b32 v254, 0
    v_mov_b32 v255, 0
    s_waitcnt vmcnt(10)
    s_barrier
    ds_read_b128 v[0:3], v82 offset:0
    ds_read_b128 v[4:7], v82 offset:1024
    ds_read_b128 v[8:11], v82 offset:2048
    ds_read_b128 v[12:15], v82 offset:3072
    ds_read_b64_tr_b16 v[32:33], v72
    ds_read_b64_tr_b16 v[34:35], v72 offset:1024
    ds_read_b64_tr_b16 v[36:37], v73
    ds_read_b64_tr_b16 v[38:39], v73 offset:1024
    ds_read_b64_tr_b16 v[40:41], v74
    ds_read_b64_tr_b16 v[42:43], v74 offset:1024
    ds_read_b64_tr_b16 v[44:45], v75
    ds_read_b64_tr_b16 v[46:47], v75 offset:1024
    ds_read_b64_tr_b16 v[48:49], v76
    ds_read_b64_tr_b16 v[50:51], v76 offset:1024
    s_waitcnt lgkmcnt(4)
    ds_read_b64_tr_b16 v[52:53], v77
    ds_read_b64_tr_b16 v[54:55], v77 offset:1024
    ds_read_b64_tr_b16 v[56:57], v78
    ds_read_b64_tr_b16 v[58:59], v78 offset:1024
    ds_read_b64_tr_b16 v[60:61], v79
    ds_read_b64_tr_b16 v[62:63], v79 offset:1024
    ds_read_b64_tr_b16 v[64:65], v80
    ds_read_b64_tr_b16 v[66:67], v80 offset:1024
    ds_read_b64_tr_b16 v[68:69], v81
    ds_read_b64_tr_b16 v[70:71], v81 offset:1024
    s_mov_b32 s40, 7
L_g1_loop_4:
    s_waitcnt vmcnt(5)
    s_barrier
    v_add_u32 v82, 40960, v82
    ds_read_b128 v[16:19], v82 offset:0
    ds_read_b128 v[20:23], v82 offset:1024
    ds_read_b128 v[24:27], v82 offset:2048
    ds_read_b128 v[28:31], v82 offset:3072
    s_waitcnt lgkmcnt(14)
    v_mfma_f32_16x16x32_bf16 v[96:99], v[32:35], v[0:3], v[96:99]
    v_mfma_f32_16x16x32_bf16 v[100:103], v[32:35], v[4:7], v[100:103]
    v_mfma_f32_16x16x32_bf16 v[104:107], v[32:35], v[8:11], v[104:107]
    v_mfma_f32_16x16x32_bf16 v[108:111], v[32:35], v[12:15], v[108:111]
    v_add_u32 v72, 40960, v72
    ds_read_b64_tr_b16 v[32:33], v72
    ds_read_b64_tr_b16 v[34:35], v72 offset:1024
    s_add_u32 m0, s30, 122880
    s_nop 0
    global_load_lds_dwordx4 v83, s[16:17]
    s_waitcnt lgkmcnt(14)
    v_mfma_f32_16x16x32_bf16 v[112:115], v[36:39], v[0:3], v[112:115]
    v_mfma_f32_16x16x32_bf16 v[116:119], v[36:39], v[4:7], v[116:119]
    v_mfma_f32_16x16x32_bf16 v[120:123], v[36:39], v[8:11], v[120:123]
    v_mfma_f32_16x16x32_bf16 v[124:127], v[36:39], v[12:15], v[124:127]
    v_add_u32 v73, 40960, v73
    ds_read_b64_tr_b16 v[36:37], v73
    ds_read_b64_tr_b16 v[38:39], v73 offset:1024
    s_add_u32 m0, s31, 122880
    s_nop 0
    global_load_lds_dwordx4 v83, s[18:19]
    v_add_u32 v83, 64, v83
    s_waitcnt lgkmcnt(14)
    v_mfma_f32_16x16x32_bf16 v[128:131], v[40:43], v[0:3], v[128:131]
    v_mfma_f32_16x16x32_bf16 v[132:135], v[40:43], v[4:7], v[132:135]
    v_mfma_f32_16x16x32_bf16 v[136:139], v[40:43], v[8:11], v[136:139]
    v_mfma_f32_16x16x32_bf16 v[140:143], v[40:43], v[12:15], v[140:143]
    v_add_u32 v74, 40960, v74
    ds_read_b64_tr_b16 v[40:41], v74
    ds_read_b64_tr_b16 v[42:43], v74 offset:1024
    s_add_u32 m0, s32, 122880
    s_mov_b64 exec, s[26:27]
    global_load_lds_dwordx4 v84, s[20:21]
    s_mov_b64 exec, -1
    v_add_u32 v84, 196608, v84
    s_waitcnt lgkmcnt(14)
    v_mfma_f32_16x16x32_bf16 v[144:147], v[44:47], v[0:3], v[144:147]
    v_mfma_f32_16x16x32_bf16 v[148:151], v[44:47], v[4:7], v[148:151]
    v_mfma_f32_16x16x32_bf16 v[152:155], v[44:47], v[8:11], v[152:155]
    v_mfma_f32_16x16x32_bf16 v[156:159], v[44:47], v[12:15], v[156:159]
    v_add_u32 v75, 40960, v75
    ds_read_b64_tr_b16 v[44:45], v75
    ds_read_b64_tr_b16 v[46:47], v75 offset:1024
    s_add_u32 m0, s33, 122880
    s_mov_b64 exec, s[28:29]
    global_load_lds_dwordx4 v85, s[22:23]
    s_mov_b64 exec, -1
    s_waitcnt lgkmcnt(14)
    v_mfma_f32_16x16x32_bf16 v[160:163], v[48:51], v[0:3], v[160:163]
    v_mfma_f32_16x16x32_bf16 v[164:167], v[48:51], v[4:7], v[164:167]
    v_mfma_f32_16x16x32_bf16 v[168:171], v[48:51], v[8:11], v[168:171]
    v_mfma_f32_16x16x32_bf16 v[172:175], v[48:51], v[12:15], v[172:175]
    v_add_u32 v76, 40960, v76
    ds_read_b64_tr_b16 v[48:49], v76
    ds_read_b64_tr_b16 v[50:51], v76 offset:1024
    s_add_u32 m0, s34, 122880
    s_mov_b64 exec, s[28:29]
    global_load_lds_dwordx4 v85, s[24:25]
    s_mov_b64 exec, -1
    v_add_u32 v85, 229376, v85
    s_waitcnt lgkmcnt(14)
    v_mfma_f32_16x16x32_bf16 v[176:179], v[52:55], v[0:3], v[176:179]
    v_mfma_f32_16x16x32_bf16 v[180:183], v[52:55], v[4:7], v[180:183]
    v_mfma_f32_16x16x32_bf16 v[184:187], v[52:55], v[8:11], v[184:187]
    v_mfma_f32_16x16x32_bf16 v[188:191], v[52:55], v[12:15], v[188:191]
    v_add_u32 v77, 40960, v77
    ds_read_b64_tr_b16 v[52:53], v77
    ds_read_b64_tr_b16 v[54:55], v77 offset:1024
    s_waitcnt lgkmcnt(14)
    v_mfma_f32_16x16x32_bf16 v[192:195], v[56:59], v[0:3], v[192:195]
    v_mfma_f32_16x16x32_bf16 v[196:199], v[56:59], v[4:7], v[196:199]
    v_mfma_f32_16x16x32_bf16 v[200:203], v[56:59], v[8:11], v[200:203]
    v_mfma_f32_16x16x32_bf16 v[204:207], v[56:59], v[12:15], v[204:207]
    v_add_u32 v78, 40960, v78
    ds_read_b64_tr_b16 v[56:57], v78
    ds_read_b64_tr_b16 v[58:59], v78 offset:1024
    s_waitcnt lgkmcnt(14)
    v_mfma_f32_16x16x32_bf16 v[208:211], v[60:63], v[0:3], v[208:211]
    v_mfma_f32_16x16x32_bf16 v[212:215], v[60:63], v[4:7], v[212:215]
    v_mfma_f32_16x16x32_bf16 v[216:219], v[60:63], v[8:11], v[216:219]
    v_mfma_f32_16x16x32_bf16 v[220:223], v[60:63], v[12:15], v[220:223]
    v_add_u32 v79, 40960, v79
    ds_read_b64_tr_b16 v[60:61], v79
    ds_read_b64_tr_b16 v[62:63], v79 offset:1024
    s_waitcnt lgkmcnt(14)
    v_mfma_f32_16x16x32_bf16 v[224:227], v[64:67], v[0:3], v[224:227]
    v_mfma_f32_16x16x32_bf16 v[228:231], v[64:67], v[4:7], v[228:231]
    v_mfma_f32_16x16x32_bf16 v[232:235], v[64:67], v[8:11], v[232:235]
    v_mfma_f32_16x16x32_bf16 v[236:239], v[64:67], v[12:15], v[236:239]
    v_add_u32 v80, 40960, v80
    ds_read_b64_tr_b16 v[64:65], v80
    ds_read_b64_tr_b16 v[66:67], v80 offset:1024
    s_waitcnt lgkmcnt(14)
    v_mfma_f32_16x16x32_bf16 v[240:243], v[68:71], v[0:3], v[240:243]
    v_mfma_f32_16x16x32_bf16 v[244:247], v[68:71], v[4:7], v[244:247]
    v_mfma_f32_16x16x32_bf16 v[248:251], v[68:71], v[8:11], v[248:251]
    v_mfma_f32_16x16x32_bf16 v[252:255], v[68:71], v[12:15], v[252:255]
    v_add_u32 v81, 40960, v81
    ds_read_b64_tr_b16 v[68:69], v81
    ds_read_b64_tr_b16 v[70:71], v81 offset:1024
    s_waitcnt vmcnt(5)
    s_barrier
    v_add_u32 v82, 40960, v82
    ds_read_b128 v[0:3], v82 offset:0
    ds_read_b128 v[4:7], v82 offset:1024
    ds_read_b128 v[8:11], v82 offset:2048
    ds_read_b128 v[12:15], v82 offset:3072
    s_waitcnt lgkmcnt(14)
    v_mfma_f32_16x16x32_bf16 v[96:99], v[32:35], v[16:19], v[96:99]
    v_mfma_f32_16x16x32_bf16 v[100:103], v[32:35], v[20:23], v[100:103]
    v_mfma_f32_16x16x32_bf16 v[104:107], v[32:35], v[24:27], v[104:107]
    v_mfma_f32_16x16x32_bf16 v[108:111], v[32:35], v[28:31], v[108:111]
    v_add_u32 v72, 40960, v72
    ds_read_b64_tr_b16 v[32:33], v72
    ds_read_b64_tr_b16 v[34:35], v72 offset:1024
    s_add_u32 m0, s30, 0
    s_nop 0
    global_load_lds_dwordx4 v83, s[16:17]
    s_waitcnt lgkmcnt(14)
    v_mfma_f32_16x16x32_bf16 v[112:115], v[36:39], v[16:19], v[112:115]
    v_mfma_f32_16x16x32_bf16 v[116:119], v[36:39], v[20:23], v[116:119]
    v_mfma_f32_16x16x32_bf16 v[120:123], v[36:39], v[24:27], v[120:123]
    v_mfma_f32_16x16x32_bf16 v[124:127], v[36:39], v[28:31], v[124:127]
    v_add_u32 v73, 40960, v73
    ds_read_b64_tr_b16 v[36:37], v73
    ds_read_b64_tr_b16 v[38:39], v73 offset:1024
    s_add_u32 m0, s31, 0
    s_nop 0
    global_load_lds_dwordx4 v83, s[18:19]
    v_add_u32 v83, 64, v83
    s_waitcnt lgkmcnt(14)
    v_mfma_f32_16x16x32_bf16 v[128:131], v[40:43], v[16:19], v[128:131]
    v_mfma_f32_16x16x32_bf16 v[132:135], v[40:43], v[20:23], v[132:135]
    v_mfma_f32_16x16x32_bf16 v[136:139], v[40:43], v[24:27], v[136:139]
    v_mfma_f32_16x16x32_bf16 v[140:143], v[40:43], v[28:31], v[140:143]
    v_add_u32 v74, 40960, v74
    ds_read_b64_tr_b16 v[40:41], v74
    ds_read_b64_tr_b16 v[42:43], v74 offset:1024
    s_add_u32 m0, s32, 0
    s_mov_b64 exec, s[26:27]
    global_load_lds_dwordx4 v84, s[20:21]
    s_mov_b64 exec, -1
    v_add_u32 v84, 196608, v84
    s_waitcnt lgkmcnt(14)
    v_mfma_f32_16x16x32_bf16 v[144:147], v[44:47], v[16:19], v[144:147]
    v_mfma_f32_16x16x32_bf16 v[148:151], v[44:47], v[20:23], v[148:151]
    v_mfma_f32_16x16x32_bf16 v[152:155], v[44:47], v[24:27], v[152:155]
    v_mfma_f32_16x16x32_bf16 v[156:159], v[44:47], v[28:31], v[156:159]
    v_add_u32 v75, 40960, v75
    ds_read_b64_tr_b16 v[44:45], v75
    ds_read_b64_tr_b16 v[46:47], v75 offset:1024
    s_add_u32 m0, s33, 0
    s_mov_b64 exec, s[28:29]
    global_load_lds_dwordx4 v85, s[22:23]
    s_mov_b64 exec, -1
    s_waitcnt lgkmcnt(14)
    v_mfma_f32_16x16x32_bf16 v[160:163], v[48:51], v[16:19], v[160:163]
    v_mfma_f32_16x16x32_bf16 v[164:167], v[48:51], v[20:23], v[164:167]
    v_mfma_f32_16x16x32_bf16 v[168:171], v[48:51], v[24:27], v[168:171]
    v_mfma_f32_16x16x32_bf16 v[172:175], v[48:51], v[28:31], v[172:175]
    v_add_u32 v76, 40960, v76
    ds_read_b64_tr_b16 v[48:49], v76
    ds_read_b64_tr_b16 v[50:51], v76 offset:1024
    s_add_u32 m0, s34, 0
    s_mov_b64 exec, s[28:29]
    global_load_lds_dwordx4 v85, s[24:25]
    s_mov_b64 exec, -1
    v_add_u32 v85, 229376, v85
    s_waitcnt lgkmcnt(14)
    v_mfma_f32_16x16x32_bf16 v[176:179], v[52:55], v[16:19], v[176:179]
    v_mfma_f32_16x16x32_bf16 v[180:183], v[52:55], v[20:23], v[180:183]
    v_mfma_f32_16x16x32_bf16 v[184:187], v[52:55], v[24:27], v[184:187]
    v_mfma_f32_16x16x32_bf16 v[188:191], v[52:55], v[28:31], v[188:191]
    v_add_u32 v77, 40960, v77
    ds_read_b64_tr_b16 v[52:53], v77
    ds_read_b64_tr_b16 v[54:55], v77 offset:1024
    s_waitcnt lgkmcnt(14)
    v_mfma_f32_16x16x32_bf16 v[192:195], v[56:59], v[16:19], v[192:195]
    v_mfma_f32_16x16x32_bf16 v[196:199], v[56:59], v[20:23], v[196:199]
    v_mfma_f32_16x16x32_bf16 v[200:203], v[56:59], v[24:27], v[200:203]
    v_mfma_f32_16x16x32_bf16 v[204:207], v[56:59], v[28:31], v[204:207]
    v_add_u32 v78, 40960, v78
    ds_read_b64_tr_b16 v[56:57], v78
    ds_read_b64_tr_b16 v[58:59], v78 offset:1024
    s_waitcnt lgkmcnt(14)
    v_mfma_f32_16x16x32_bf16 v[208:211], v[60:63], v[16:19], v[208:211]
    v_mfma_f32_16x16x32_bf16 v[212:215], v[60:63], v[20:23], v[212:215]
    v_mfma_f32_16x16x32_bf16 v[216:219], v[60:63], v[24:27], v[216:219]
    v_mfma_f32_16x16x32_bf16 v[220:223], v[60:63], v[28:31], v[220:223]
    v_add_u32 v79, 40960, v79
    ds_read_b64_tr_b16 v[60:61], v79
    ds_read_b64_tr_b16 v[62:63], v79 offset:1024
    s_waitcnt lgkmcnt(14)
    v_mfma_f32_16x16x32_bf16 v[224:227], v[64:67], v[16:19], v[224:227]
    v_mfma_f32_16x16x32_bf16 v[228:231], v[64:67], v[20:23], v[228:231]
    v_mfma_f32_16x16x32_bf16 v[232:235], v[64:67], v[24:27], v[232:235]
    v_mfma_f32_16x16x32_bf16 v[236:239], v[64:67], v[28:31], v[236:239]
    v_add_u32 v80, 40960, v80
    ds_read_b64_tr_b16 v[64:65], v80
    ds_read_b64_tr_b16 v[66:67], v80 offset:1024
    s_waitcnt lgkmcnt(14)
    v_mfma_f32_16x16x32_bf16 v[240:243], v[68:71], v[16:19], v[240:243]
    v_mfma_f32_16x16x32_bf16 v[244:247], v[68:71], v[20:23], v[244:247]
    v_mfma_f32_16x16x32_bf16 v[248:251], v[68:71], v[24:27], v[248:251]
    v_mfma_f32_16x16x32_bf16 v[252:255], v[68:71], v[28:31], v[252:255]
    v_add_u32 v81, 40960, v81
    ds_read_b64_tr_b16 v[68:69], v81
    ds_read_b64_tr_b16 v[70:71], v81 offset:1024
    s_waitcnt vmcnt(5)
    s_barrier
    v_add_u32 v82, 40960, v82
    ds_read_b128 v[16:19], v82 offset:0
    ds_read_b128 v[20:23], v82 offset:1024
    ds_read_b128 v[24:27], v82 offset:2048
    ds_read_b128 v[28:31], v82 offset:3072
    s_waitcnt lgkmcnt(14)
    v_mfma_f32_16x16x32_bf16 v[96:99], v[32:35], v[0:3], v[96:99]
    v_mfma_f32_16x16x32_bf16 v[100:103], v[32:35], v[4:7], v[100:103]
    v_mfma_f32_16x16x32_bf16 v[104:107], v[32:35], v[8:11], v[104:107]
    v_mfma_f32_16x16x32_bf16 v[108:111], v[32:35], v[12:15], v[108:111]
    v_add_u32 v72, 40960, v72
    ds_read_b64_tr_b16 v[32:33], v72
    ds_read_b64_tr_b16 v[34:35], v72 offset:1024
    s_add_u32 m0, s30, 40960
    s_nop 0
    global_load_lds_dwordx4 v83, s[16:17]
    s_waitcnt lgkmcnt(14)
    v_mfma_f32_16x16x32_bf16 v[112:115], v[36:39], v[0:3], v[112:115]
    v_mfma_f32_16x16x32_bf16 v[116:119], v[36:39], v[4:7], v[116:119]
    v_mfma_f32_16x16x32_bf16 v[120:123], v[36:39], v[8:11], v[120:123]
    v_mfma_f32_16x16x32_bf16 v[124:127], v[36:39], v[12:15], v[124:127]
    v_add_u32 v73, 40960, v73
    ds_read_b64_tr_b16 v[36:37], v73
    ds_read_b64_tr_b16 v[38:39], v73 offset:1024
    s_add_u32 m0, s31, 40960
    s_nop 0
    global_load_lds_dwordx4 v83, s[18:19]
    v_add_u32 v83, 64, v83
    s_waitcnt lgkmcnt(14)
    v_mfma_f32_16x16x32_bf16 v[128:131], v[40:43], v[0:3], v[128:131]
    v_mfma_f32_16x16x32_bf16 v[132:135], v[40:43], v[4:7], v[132:135]
    v_mfma_f32_16x16x32_bf16 v[136:139], v[40:43], v[8:11], v[136:139]
    v_mfma_f32_16x16x32_bf16 v[140:143], v[40:43], v[12:15], v[140:143]
    v_add_u32 v74, 40960, v74
    ds_read_b64_tr_b16 v[40:41], v74
    ds_read_b64_tr_b16 v[42:43], v74 offset:1024
    s_add_u32 m0, s32, 40960
    s_mov_b64 exec, s[26:27]
    global_load_lds_dwordx4 v84, s[20:21]
    s_mov_b64 exec, -1
    v_add_u32 v84, 196608, v84
    s_waitcnt lgkmcnt(14)
    v_mfma_f32_16x16x32_bf16 v[144:147], v[44:47], v[0:3], v[144:147]
    v_mfma_f32_16x16x32_bf16 v[148:151], v[44:47], v[4:7], v[148:151]
    v_mfma_f32_16x16x32_bf16 v[152:155], v[44:47], v[8:11], v[152:155]
    v_mfma_f32_16x16x32_bf16 v[156:159], v[44:47], v[12:15], v[156:159]
    v_add_u32 v75, 40960, v75
    ds_read_b64_tr_b16 v[44:45], v75
    ds_read_b64_tr_b16 v[46:47], v75 offset:1024
    s_add_u32 m0, s33, 40960
    s_mov_b64 exec, s[28:29]
    global_load_lds_dwordx4 v85, s[22:23]
    s_mov_b64 exec, -1
    s_waitcnt lgkmcnt(14)
    v_mfma_f32_16x16x32_bf16 v[160:163], v[48:51], v[0:3], v[160:163]
    v_mfma_f32_16x16x32_bf16 v[164:167], v[48:51], v[4:7], v[164:167]
    v_mfma_f32_16x16x32_bf16 v[168:171], v[48:51], v[8:11], v[168:171]
    v_mfma_f32_16x16x32_bf16 v[172:175], v[48:51], v[12:15], v[172:175]
    v_add_u32 v76, 40960, v76
    ds_read_b64_tr_b16 v[48:49], v76
    ds_read_b64_tr_b16 v[50:51], v76 offset:1024
    s_add_u32 m0, s34, 40960
    s_mov_b64 exec, s[28:29]
    global_load_lds_dwordx4 v85, s[24:25]
    s_mov_b64 exec, -1
    v_add_u32 v85, 229376, v85
    s_waitcnt lgkmcnt(14)
    v_mfma_f32_16x16x32_bf16 v[176:179], v[52:55], v[0:3], v[176:179]
    v_mfma_f32_16x16x32_bf16 v[180:183], v[52:55], v[4:7], v[180:183]
    v_mfma_f32_16x16x32_bf16 v[184:187], v[52:55], v[8:11], v[184:187]
    v_mfma_f32_16x16x32_bf16 v[188:191], v[52:55], v[12:15], v[188:191]
    v_add_u32 v77, 40960, v77
    ds_read_b64_tr_b16 v[52:53], v77
    ds_read_b64_tr_b16 v[54:55], v77 offset:1024
    s_waitcnt lgkmcnt(14)
    v_mfma_f32_16x16x32_bf16 v[192:195], v[56:59], v[0:3], v[192:195]
    v_mfma_f32_16x16x32_bf16 v[196:199], v[56:59], v[4:7], v[196:199]
    v_mfma_f32_16x16x32_bf16 v[200:203], v[56:59], v[8:11], v[200:203]
    v_mfma_f32_16x16x32_bf16 v[204:207], v[56:59], v[12:15], v[204:207]
    v_add_u32 v78, 40960, v78
    ds_read_b64_tr_b16 v[56:57], v78
    ds_read_b64_tr_b16 v[58:59], v78 offset:1024
    s_waitcnt lgkmcnt(14)
    v_mfma_f32_16x16x32_bf16 v[208:211], v[60:63], v[0:3], v[208:211]
    v_mfma_f32_16x16x32_bf16 v[212:215], v[60:63], v[4:7], v[212:215]
    v_mfma_f32_16x16x32_bf16 v[216:219], v[60:63], v[8:11], v[216:219]
    v_mfma_f32_16x16x32_bf16 v[220:223], v[60:63], v[12:15], v[220:223]
    v_add_u32 v79, 40960, v79
    ds_read_b64_tr_b16 v[60:61], v79
    ds_read_b64_tr_b16 v[62:63], v79 offset:1024
    s_waitcnt lgkmcnt(14)
    v_mfma_f32_16x16x32_bf16 v[224:227], v[64:67], v[0:3], v[224:227]
    v_mfma_f32_16x16x32_bf16 v[228:231], v[64:67], v[4:7], v[228:231]
    v_mfma_f32_16x16x32_bf16 v[232:235], v[64:67], v[8:11], v[232:235]
    v_mfma_f32_16x16x32_bf16 v[236:239], v[64:67], v[12:15], v[236:239]
    v_add_u32 v80, 40960, v80
    ds_read_b64_tr_b16 v[64:65], v80
    ds_read_b64_tr_b16 v[66:67], v80 offset:1024
    s_waitcnt lgkmcnt(14)
    v_mfma_f32_16x16x32_bf16 v[240:243], v[68:71], v[0:3], v[240:243]
    v_mfma_f32_16x16x32_bf16 v[244:247], v[68:71], v[4:7], v[244:247]
    v_mfma_f32_16x16x32_bf16 v[248:251], v[68:71], v[8:11], v[248:251]
    v_mfma_f32_16x16x32_bf16 v[252:255], v[68:71], v[12:15], v[252:255]
    v_add_u32 v81, 40960, v81
    ds_read_b64_tr_b16 v[68:69], v81
    ds_read_b64_tr_b16 v[70:71], v81 offset:1024
    s_waitcnt vmcnt(5)
    s_barrier
    v_add_u32 v82, 4294844416, v82
    ds_read_b128 v[0:3], v82 offset:0
    ds_read_b128 v[4:7], v82 offset:1024
    ds_read_b128 v[8:11], v82 offset:2048
    ds_read_b128 v[12:15], v82 offset:3072
    s_waitcnt lgkmcnt(14)
    v_mfma_f32_16x16x32_bf16 v[96:99], v[32:35], v[16:19], v[96:99]
    v_mfma_f32_16x16x32_bf16 v[100:103], v[32:35], v[20:23], v[100:103]
    v_mfma_f32_16x16x32_bf16 v[104:107], v[32:35], v[24:27], v[104:107]
    v_mfma_f32_16x16x32_bf16 v[108:111], v[32:35], v[28:31], v[108:111]
    v_add_u32 v72, 4294844416, v72
    ds_read_b64_tr_b16 v[32:33], v72
    ds_read_b64_tr_b16 v[34:35], v72 offset:1024
    s_add_u32 m0, s30, 81920
    s_nop 0
    global_load_lds_dwordx4 v83, s[16:17]
    s_waitcnt lgkmcnt(14)
    v_mfma_f32_16x16x32_bf16 v[112:115], v[36:39], v[16:19], v[112:115]
    v_mfma_f32_16x16x32_bf16 v[116:119], v[36:39], v[20:23], v[116:119]
    v_mfma_f32_16x16x32_bf16 v[120:123], v[36:39], v[24:27], v[120:123]
    v_mfma_f32_16x16x32_bf16 v[124:127], v[36:39], v[28:31], v[124:127]
    v_add_u32 v73, 4294844416, v73
    ds_read_b64_tr_b16 v[36:37], v73
    ds_read_b64_tr_b16 v[38:39], v73 offset:1024
    s_add_u32 m0, s31, 81920
    s_nop 0
    global_load_lds_dwordx4 v83, s[18:19]
    v_add_u32 v83, 64, v83
    s_waitcnt lgkmcnt(14)
    v_mfma_f32_16x16x32_bf16 v[128:131], v[40:43], v[16:19], v[128:131]
    v_mfma_f32_16x16x32_bf16 v[132:135], v[40:43], v[20:23], v[132:135]
    v_mfma_f32_16x16x32_bf16 v[136:139], v[40:43], v[24:27], v[136:139]
    v_mfma_f32_16x16x32_bf16 v[140:143], v[40:43], v[28:31], v[140:143]
    v_add_u32 v74, 4294844416, v74
    ds_read_b64_tr_b16 v[40:41], v74
    ds_read_b64_tr_b16 v[42:43], v74 offset:1024
    s_add_u32 m0, s32, 81920
    s_mov_b64 exec, s[26:27]
    global_load_lds_dwordx4 v84, s[20:21]
    s_mov_b64 exec, -1
    v_add_u32 v84, 196608, v84
    s_waitcnt lgkmcnt(14)
    v_mfma_f32_16x16x32_bf16 v[144:147], v[44:47], v[16:19], v[144:147]
    v_mfma_f32_16x16x32_bf16 v[148:151], v[44:47], v[20:23], v[148:151]
    v_mfma_f32_16x16x32_bf16 v[152:155], v[44:47], v[24:27], v[152:155]
    v_mfma_f32_16x16x32_bf16 v[156:159], v[44:47], v[28:31], v[156:159]
    v_add_u32 v75, 4294844416, v75
    ds_read_b64_tr_b16 v[44:45], v75
    ds_read_b64_tr_b16 v[46:47], v75 offset:1024
    s_add_u32 m0, s33, 81920
    s_mov_b64 exec, s[28:29]
    global_load_lds_dwordx4 v85, s[22:23]
    s_mov_b64 exec, -1
    s_waitcnt lgkmcnt(14)
    v_mfma_f32_16x16x32_bf16 v[160:163], v[48:51], v[16:19], v[160:163]
    v_mfma_f32_16x16x32_bf16 v[164:167], v[48:51], v[20:23], v[164:167]
    v_mfma_f32_16x16x32_bf16 v[168:171], v[48:51], v[24:27], v[168:171]
    v_mfma_f32_16x16x32_bf16 v[172:175], v[48:51], v[28:31], v[172:175]
    v_add_u32 v76, 4294844416, v76
    ds_read_b64_tr_b16 v[48:49], v76
    ds_read_b64_tr_b16 v[50:51], v76 offset:1024
    s_add_u32 m0, s34, 81920
    s_mov_b64 exec, s[28:29]
    global_load_lds_dwordx4 v85, s[24:25]
    s_mov_b64 exec, -1
    v_add_u32 v85, 229376, v85
    s_waitcnt lgkmcnt(14)
    v_mfma_f32_16x16x32_bf16 v[176:179], v[52:55], v[16:19], v[176:179]
    v_mfma_f32_16x16x32_bf16 v[180:183], v[52:55], v[20:23], v[180:183]
    v_mfma_f32_16x16x32_bf16 v[184:187], v[52:55], v[24:27], v[184:187]
    v_mfma_f32_16x16x32_bf16 v[188:191], v[52:55], v[28:31], v[188:191]
    v_add_u32 v77, 4294844416, v77
    ds_read_b64_tr_b16 v[52:53], v77
    ds_read_b64_tr_b16 v[54:55], v77 offset:1024
    s_waitcnt lgkmcnt(14)
    v_mfma_f32_16x16x32_bf16 v[192:195], v[56:59], v[16:19], v[192:195]
    v_mfma_f32_16x16x32_bf16 v[196:199], v[56:59], v[20:23], v[196:199]
    v_mfma_f32_16x16x32_bf16 v[200:203], v[56:59], v[24:27], v[200:203]
    v_mfma_f32_16x16x32_bf16 v[204:207], v[56:59], v[28:31], v[204:207]
    v_add_u32 v78, 4294844416, v78
    ds_read_b64_tr_b16 v[56:57], v78
    ds_read_b64_tr_b16 v[58:59], v78 offset:1024
    s_waitcnt lgkmcnt(14)
    v_mfma_f32_16x16x32_bf16 v[208:211], v[60:63], v[16:19], v[208:211]
    v_mfma_f32_16x16x32_bf16 v[212:215], v[60:63], v[20:23], v[212:215]
    v_mfma_f32_16x16x32_bf16 v[216:219], v[60:63], v[24:27], v[216:219]
    v_mfma_f32_16x16x32_bf16 v[220:223], v[60:63], v[28:31], v[220:223]
    v_add_u32 v79, 4294844416, v79
    ds_read_b64_tr_b16 v[60:61], v79
    ds_read_b64_tr_b16 v[62:63], v79 offset:1024
    s_waitcnt lgkmcnt(14)
    v_mfma_f32_16x16x32_bf16 v[224:227], v[64:67], v[16:19], v[224:227]
    v_mfma_f32_16x16x32_bf16 v[228:231], v[64:67], v[20:23], v[228:231]
    v_mfma_f32_16x16x32_bf16 v[232:235], v[64:67], v[24:27], v[232:235]
    v_mfma_f32_16x16x32_bf16 v[236:239], v[64:67], v[28:31], v[236:239]
    v_add_u32 v80, 4294844416, v80
    ds_read_b64_tr_b16 v[64:65], v80
    ds_read_b64_tr_b16 v[66:67], v80 offset:1024
    s_waitcnt lgkmcnt(14)
    v_mfma_f32_16x16x32_bf16 v[240:243], v[68:71], v[16:19], v[240:243]
    v_mfma_f32_16x16x32_bf16 v[244:247], v[68:71], v[20:23], v[244:247]
    v_mfma_f32_16x16x32_bf16 v[248:251], v[68:71], v[24:27], v[248:251]
    v_mfma_f32_16x16x32_bf16 v[252:255], v[68:71], v[28:31], v[252:255]
    v_add_u32 v81, 4294844416, v81
    ds_read_b64_tr_b16 v[68:69], v81
    ds_read_b64_tr_b16 v[70:71], v81 offset:1024
    s_sub_u32 s40, s40, 1
    s_cmp_lg_u32 s40, 0
    s_cbranch_scc1 L_g1_loop_4
    s_waitcnt vmcnt(5)
    s_barrier
    v_add_u32 v82, 40960, v82
    ds_read_b128 v[16:19], v82 offset:0
    ds_read_b128 v[20:23], v82 offset:1024
    ds_read_b128 v[24:27], v82 offset:2048
    ds_read_b128 v[28:31], v82 offset:3072
    s_waitcnt lgkmcnt(14)
    v_mfma_f32_16x16x32_bf16 v[96:99], v[32:35], v[0:3], v[96:99]
    v_mfma_f32_16x16x32_bf16 v[100:103], v[32:35], v[4:7], v[100:103]
    v_mfma_f32_16x16x32_bf16 v[104:107], v[32:35], v[8:11], v[104:107]
    v_mfma_f32_16x16x32_bf16 v[108:111], v[32:35], v[12:15], v[108:111]
    v_add_u32 v72, 40960, v72
    ds_read_b64_tr_b16 v[32:33], v72
    ds_read_b64_tr_b16 v[34:35], v72 offset:1024
    s_add_u32 m0, s30, 122880
    s_nop 0
    global_load_lds_dwordx4 v83, s[16:17]
    s_waitcnt lgkmcnt(14)
    v_mfma_f32_16x16x32_bf16 v[112:115], v[36:39], v[0:3], v[112:115]
    v_mfma_f32_16x16x32_bf16 v[116:119], v[36:39], v[4:7], v[116:119]
    v_mfma_f32_16x16x32_bf16 v[120:123], v[36:39], v[8:11], v[120:123]
    v_mfma_f32_16x16x32_bf16 v[124:127], v[36:39], v[12:15], v[124:127]
    v_add_u32 v73, 40960, v73
    ds_read_b64_tr_b16 v[36:37], v73
    ds_read_b64_tr_b16 v[38:39], v73 offset:1024
    s_add_u32 m0, s31, 122880
    s_nop 0
    global_load_lds_dwordx4 v83, s[18:19]
    v_add_u32 v83, 64, v83
    s_waitcnt lgkmcnt(14)
    v_mfma_f32_16x16x32_bf16 v[128:131], v[40:43], v[0:3], v[128:131]
    v_mfma_f32_16x16x32_bf16 v[132:135], v[40:43], v[4:7], v[132:135]
    v_mfma_f32_16x16x32_bf16 v[136:139], v[40:43], v[8:11], v[136:139]
    v_mfma_f32_16x16x32_bf16 v[140:143], v[40:43], v[12:15], v[140:143]
    v_add_u32 v74, 40960, v74
    ds_read_b64_tr_b16 v[40:41], v74
    ds_read_b64_tr_b16 v[42:43], v74 offset:1024
    s_add_u32 m0, s32, 122880
    s_mov_b64 exec, s[26:27]
    global_load_lds_dwordx4 v84, s[20:21]
    s_mov_b64 exec, -1
    v_add_u32 v84, 196608, v84
    s_waitcnt lgkmcnt(14)
    v_mfma_f32_16x16x32_bf16 v[144:147], v[44:47], v[0:3], v[144:147]
    v_mfma_f32_16x16x32_bf16 v[148:151], v[44:47], v[4:7], v[148:151]
    v_mfma_f32_16x16x32_bf16 v[152:155], v[44:47], v[8:11], v[152:155]
    v_mfma_f32_16x16x32_bf16 v[156:159], v[44:47], v[12:15], v[156:159]
    v_add_u32 v75, 40960, v75
    ds_read_b64_tr_b16 v[44:45], v75
    ds_read_b64_tr_b16 v[46:47], v75 offset:1024
    s_add_u32 m0, s33, 122880
    s_mov_b64 exec, s[28:29]
    global_load_lds_dwordx4 v85, s[22:23]
    s_mov_b64 exec, -1
    s_waitcnt lgkmcnt(14)
    v_mfma_f32_16x16x32_bf16 v[160:163], v[48:51], v[0:3], v[160:163]
    v_mfma_f32_16x16x32_bf16 v[164:167], v[48:51], v[4:7], v[164:167]
    v_mfma_f32_16x16x32_bf16 v[168:171], v[48:51], v[8:11], v[168:171]
    v_mfma_f32_16x16x32_bf16 v[172:175], v[48:51], v[12:15], v[172:175]
    v_add_u32 v76, 40960, v76
    ds_read_b64_tr_b16 v[48:49], v76
    ds_read_b64_tr_b16 v[50:51], v76 offset:1024
    s_add_u32 m0, s34, 122880
    s_mov_b64 exec, s[28:29]
    global_load_lds_dwordx4 v85, s[24:25]
    s_mov_b64 exec, -1
    v_add_u32 v85, 229376, v85
    s_waitcnt lgkmcnt(14)
    v_mfma_f32_16x16x32_bf16 v[176:179], v[52:55], v[0:3], v[176:179]
    v_mfma_f32_16x16x32_bf16 v[180:183], v[52:55], v[4:7], v[180:183]
    v_mfma_f32_16x16x32_bf16 v[184:187], v[52:55], v[8:11], v[184:187]
    v_mfma_f32_16x16x32_bf16 v[188:191], v[52:55], v[12:15], v[188:191]
    v_add_u32 v77, 40960, v77
    ds_read_b64_tr_b16 v[52:53], v77
    ds_read_b64_tr_b16 v[54:55], v77 offset:1024
    s_waitcnt lgkmcnt(14)
    v_mfma_f32_16x16x32_bf16 v[192:195], v[56:59], v[0:3], v[192:195]
    v_mfma_f32_16x16x32_bf16 v[196:199], v[56:59], v[4:7], v[196:199]
    v_mfma_f32_16x16x32_bf16 v[200:203], v[56:59], v[8:11], v[200:203]
    v_mfma_f32_16x16x32_bf16 v[204:207], v[56:59], v[12:15], v[204:207]
    v_add_u32 v78, 40960, v78
    ds_read_b64_tr_b16 v[56:57], v78
    ds_read_b64_tr_b16 v[58:59], v78 offset:1024
    s_waitcnt lgkmcnt(14)
    v_mfma_f32_16x16x32_bf16 v[208:211], v[60:63], v[0:3], v[208:211]
    v_mfma_f32_16x16x32_bf16 v[212:215], v[60:63], v[4:7], v[212:215]
    v_mfma_f32_16x16x32_bf16 v[216:219], v[60:63], v[8:11], v[216:219]
    v_mfma_f32_16x16x32_bf16 v[220:223], v[60:63], v[12:15], v[220:223]
    v_add_u32 v79, 40960, v79
    ds_read_b64_tr_b16 v[60:61], v79
    ds_read_b64_tr_b16 v[62:63], v79 offset:1024
    s_waitcnt lgkmcnt(14)
    v_mfma_f32_16x16x32_bf16 v[224:227], v[64:67], v[0:3], v[224:227]
    v_mfma_f32_16x16x32_bf16 v[228:231], v[64:67], v[4:7], v[228:231]
    v_mfma_f32_16x16x32_bf16 v[232:235], v[64:67], v[8:11], v[232:235]
    v_mfma_f32_16x16x32_bf16 v[236:239], v[64:67], v[12:15], v[236:239]
    v_add_u32 v80, 40960, v80
    ds_read_b64_tr_b16 v[64:65], v80
    ds_read_b64_tr_b16 v[66:67], v80 offset:1024
    s_waitcnt lgkmcnt(14)
    v_mfma_f32_16x16x32_bf16 v[240:243], v[68:71], v[0:3], v[240:243]
    v_mfma_f32_16x16x32_bf16 v[244:247], v[68:71], v[4:7], v[244:247]
    v_mfma_f32_16x16x32_bf16 v[248:251], v[68:71], v[8:11], v[248:251]
    v_mfma_f32_16x16x32_bf16 v[252:255], v[68:71], v[12:15], v[252:255]
    v_add_u32 v81, 40960, v81
    ds_read_b64_tr_b16 v[68:69], v81
    ds_read_b64_tr_b16 v[70:71], v81 offset:1024
    s_waitcnt vmcnt(5)
    s_barrier
    v_add_u32 v82, 40960, v82
    ds_read_b128 v[0:3], v82 offset:0
    ds_read_b128 v[4:7], v82 offset:1024
    ds_read_b128 v[8:11], v82 offset:2048
    ds_read_b128 v[12:15], v82 offset:3072
    s_waitcnt lgkmcnt(14)
    v_mfma_f32_16x16x32_bf16 v[96:99], v[32:35], v[16:19], v[96:99]
    v_mfma_f32_16x16x32_bf16 v[100:103], v[32:35], v[20:23], v[100:103]
    v_mfma_f32_16x16x32_bf16 v[104:107], v[32:35], v[24:27], v[104:107]
    v_mfma_f32_16x16x32_bf16 v[108:111], v[32:35], v[28:31], v[108:111]
    v_add_u32 v72, 40960, v72
    ds_read_b64_tr_b16 v[32:33], v72
    ds_read_b64_tr_b16 v[34:35], v72 offset:1024
    s_waitcnt lgkmcnt(14)
    v_mfma_f32_16x16x32_bf16 v[112:115], v[36:39], v[16:19], v[112:115]
    v_mfma_f32_16x16x32_bf16 v[116:119], v[36:39], v[20:23], v[116:119]
    v_mfma_f32_16x16x32_bf16 v[120:123], v[36:39], v[24:27], v[120:123]
    v_mfma_f32_16x16x32_bf16 v[124:127], v[36:39], v[28:31], v[124:127]
    v_add_u32 v73, 40960, v73
    ds_read_b64_tr_b16 v[36:37], v73
    ds_read_b64_tr_b16 v[38:39], v73 offset:1024
    s_waitcnt lgkmcnt(14)
    v_mfma_f32_16x16x32_bf16 v[128:131], v[40:43], v[16:19], v[128:131]
    v_mfma_f32_16x16x32_bf16 v[132:135], v[40:43], v[20:23], v[132:135]
    v_mfma_f32_16x16x32_bf16 v[136:139], v[40:43], v[24:27], v[136:139]
    v_mfma_f32_16x16x32_bf16 v[140:143], v[40:43], v[28:31], v[140:143]
    v_add_u32 v74, 40960, v74
    ds_read_b64_tr_b16 v[40:41], v74
    ds_read_b64_tr_b16 v[42:43], v74 offset:1024
    s_waitcnt lgkmcnt(14)
    v_mfma_f32_16x16x32_bf16 v[144:147], v[44:47], v[16:19], v[144:147]
    v_mfma_f32_16x16x32_bf16 v[148:151], v[44:47], v[20:23], v[148:151]
    v_mfma_f32_16x16x32_bf16 v[152:155], v[44:47], v[24:27], v[152:155]
    v_mfma_f32_16x16x32_bf16 v[156:159], v[44:47], v[28:31], v[156:159]
    v_add_u32 v75, 40960, v75
    ds_read_b64_tr_b16 v[44:45], v75
    ds_read_b64_tr_b16 v[46:47], v75 offset:1024
    s_waitcnt lgkmcnt(14)
    v_mfma_f32_16x16x32_bf16 v[160:163], v[48:51], v[16:19], v[160:163]
    v_mfma_f32_16x16x32_bf16 v[164:167], v[48:51], v[20:23], v[164:167]
    v_mfma_f32_16x16x32_bf16 v[168:171], v[48:51], v[24:27], v[168:171]
    v_mfma_f32_16x16x32_bf16 v[172:175], v[48:51], v[28:31], v[172:175]
    v_add_u32 v76, 40960, v76
    ds_read_b64_tr_b16 v[48:49], v76
    ds_read_b64_tr_b16 v[50:51], v76 offset:1024
    s_waitcnt lgkmcnt(14)
    v_mfma_f32_16x16x32_bf16 v[176:179], v[52:55], v[16:19], v[176:179]
    v_mfma_f32_16x16x32_bf16 v[180:183], v[52:55], v[20:23], v[180:183]
    v_mfma_f32_16x16x32_bf16 v[184:187], v[52:55], v[24:27], v[184:187]
    v_mfma_f32_16x16x32_bf16 v[188:191], v[52:55], v[28:31], v[188:191]
    v_add_u32 v77, 40960, v77
    ds_read_b64_tr_b16 v[52:53], v77
    ds_read_b64_tr_b16 v[54:55], v77 offset:1024
    s_waitcnt lgkmcnt(14)
    v_mfma_f32_16x16x32_bf16 v[192:195], v[56:59], v[16:19], v[192:195]
    v_mfma_f32_16x16x32_bf16 v[196:199], v[56:59], v[20:23], v[196:199]
    v_mfma_f32_16x16x32_bf16 v[200:203], v[56:59], v[24:27], v[200:203]
    v_mfma_f32_16x16x32_bf16 v[204:207], v[56:59], v[28:31], v[204:207]
    v_add_u32 v78, 40960, v78
    ds_read_b64_tr_b16 v[56:57], v78
    ds_read_b64_tr_b16 v[58:59], v78 offset:1024
    s_waitcnt lgkmcnt(14)
    v_mfma_f32_16x16x32_bf16 v[208:211], v[60:63], v[16:19], v[208:211]
    v_mfma_f32_16x16x32_bf16 v[212:215], v[60:63], v[20:23], v[212:215]
    v_mfma_f32_16x16x32_bf16 v[216:219], v[60:63], v[24:27], v[216:219]
    v_mfma_f32_16x16x32_bf16 v[220:223], v[60:63], v[28:31], v[220:223]
    v_add_u32 v79, 40960, v79
    ds_read_b64_tr_b16 v[60:61], v79
    ds_read_b64_tr_b16 v[62:63], v79 offset:1024
    s_waitcnt lgkmcnt(14)
    v_mfma_f32_16x16x32_bf16 v[224:227], v[64:67], v[16:19], v[224:227]
    v_mfma_f32_16x16x32_bf16 v[228:231], v[64:67], v[20:23], v[228:231]
    v_mfma_f32_16x16x32_bf16 v[232:235], v[64:67], v[24:27], v[232:235]
    v_mfma_f32_16x16x32_bf16 v[236:239], v[64:67], v[28:31], v[236:239]
    v_add_u32 v80, 40960, v80
    ds_read_b64_tr_b16 v[64:65], v80
    ds_read_b64_tr_b16 v[66:67], v80 offset:1024
    s_waitcnt lgkmcnt(14)
    v_mfma_f32_16x16x32_bf16 v[240:243], v[68:71], v[16:19], v[240:243]
    v_mfma_f32_16x16x32_bf16 v[244:247], v[68:71], v[20:23], v[244:247]
    v_mfma_f32_16x16x32_bf16 v[248:251], v[68:71], v[24:27], v[248:251]
    v_mfma_f32_16x16x32_bf16 v[252:255], v[68:71], v[28:31], v[252:255]
    v_add_u32 v81, 40960, v81
    ds_read_b64_tr_b16 v[68:69], v81
    ds_read_b64_tr_b16 v[70:71], v81 offset:1024
    s_waitcnt vmcnt(0)
    s_barrier
    v_add_u32 v82, 40960, v82
    ds_read_b128 v[16:19], v82 offset:0
    ds_read_b128 v[20:23], v82 offset:1024
    ds_read_b128 v[24:27], v82 offset:2048
    ds_read_b128 v[28:31], v82 offset:3072
    s_waitcnt lgkmcnt(14)
    v_mfma_f32_16x16x32_bf16 v[96:99], v[32:35], v[0:3], v[96:99]
    v_mfma_f32_16x16x32_bf16 v[100:103], v[32:35], v[4:7], v[100:103]
    v_mfma_f32_16x16x32_bf16 v[104:107], v[32:35], v[8:11], v[104:107]
    v_mfma_f32_16x16x32_bf16 v[108:111], v[32:35], v[12:15], v[108:111]
    v_add_u32 v72, 40960, v72
    ds_read_b64_tr_b16 v[32:33], v72
    ds_read_b64_tr_b16 v[34:35], v72 offset:1024
    s_waitcnt lgkmcnt(14)
    v_mfma_f32_16x16x32_bf16 v[112:115], v[36:39], v[0:3], v[112:115]
    v_mfma_f32_16x16x32_bf16 v[116:119], v[36:39], v[4:7], v[116:119]
    v_mfma_f32_16x16x32_bf16 v[120:123], v[36:39], v[8:11], v[120:123]
    v_mfma_f32_16x16x32_bf16 v[124:127], v[36:39], v[12:15], v[124:127]
    v_add_u32 v73, 40960, v73
    ds_read_b64_tr_b16 v[36:37], v73
    ds_read_b64_tr_b16 v[38:39], v73 offset:1024
    s_waitcnt lgkmcnt(14)
    v_mfma_f32_16x16x32_bf16 v[128:131], v[40:43], v[0:3], v[128:131]
    v_mfma_f32_16x16x32_bf16 v[132:135], v[40:43], v[4:7], v[132:135]
    v_mfma_f32_16x16x32_bf16 v[136:139], v[40:43], v[8:11], v[136:139]
    v_mfma_f32_16x16x32_bf16 v[140:143], v[40:43], v[12:15], v[140:143]
    v_add_u32 v74, 40960, v74
    ds_read_b64_tr_b16 v[40:41], v74
    ds_read_b64_tr_b16 v[42:43], v74 offset:1024
    s_waitcnt lgkmcnt(14)
    v_mfma_f32_16x16x32_bf16 v[144:147], v[44:47], v[0:3], v[144:147]
    v_mfma_f32_16x16x32_bf16 v[148:151], v[44:47], v[4:7], v[148:151]
    v_mfma_f32_16x16x32_bf16 v[152:155], v[44:47], v[8:11], v[152:155]
    v_mfma_f32_16x16x32_bf16 v[156:159], v[44:47], v[12:15], v[156:159]
    v_add_u32 v75, 40960, v75
    ds_read_b64_tr_b16 v[44:45], v75
    ds_read_b64_tr_b16 v[46:47], v75 offset:1024
    s_waitcnt lgkmcnt(14)
    v_mfma_f32_16x16x32_bf16 v[160:163], v[48:51], v[0:3], v[160:163]
    v_mfma_f32_16x16x32_bf16 v[164:167], v[48:51], v[4:7], v[164:167]
    v_mfma_f32_16x16x32_bf16 v[168:171], v[48:51], v[8:11], v[168:171]
    v_mfma_f32_16x16x32_bf16 v[172:175], v[48:51], v[12:15], v[172:175]
    v_add_u32 v76, 40960, v76
    ds_read_b64_tr_b16 v[48:49], v76
    ds_read_b64_tr_b16 v[50:51], v76 offset:1024
    s_waitcnt lgkmcnt(14)
    v_mfma_f32_16x16x32_bf16 v[176:179], v[52:55], v[0:3], v[176:179]
    v_mfma_f32_16x16x32_bf16 v[180:183], v[52:55], v[4:7], v[180:183]
    v_mfma_f32_16x16x32_bf16 v[184:187], v[52:55], v[8:11], v[184:187]
    v_mfma_f32_16x16x32_bf16 v[188:191], v[52:55], v[12:15], v[188:191]
    v_add_u32 v77, 40960, v77
    ds_read_b64_tr_b16 v[52:53], v77
    ds_read_b64_tr_b16 v[54:55], v77 offset:1024
    s_waitcnt lgkmcnt(14)
    v_mfma_f32_16x16x32_bf16 v[192:195], v[56:59], v[0:3], v[192:195]
    v_mfma_f32_16x16x32_bf16 v[196:199], v[56:59], v[4:7], v[196:199]
    v_mfma_f32_16x16x32_bf16 v[200:203], v[56:59], v[8:11], v[200:203]
    v_mfma_f32_16x16x32_bf16 v[204:207], v[56:59], v[12:15], v[204:207]
    v_add_u32 v78, 40960, v78
    ds_read_b64_tr_b16 v[56:57], v78
    ds_read_b64_tr_b16 v[58:59], v78 offset:1024
    s_waitcnt lgkmcnt(14)
    v_mfma_f32_16x16x32_bf16 v[208:211], v[60:63], v[0:3], v[208:211]
    v_mfma_f32_16x16x32_bf16 v[212:215], v[60:63], v[4:7], v[212:215]
    v_mfma_f32_16x16x32_bf16 v[216:219], v[60:63], v[8:11], v[216:219]
    v_mfma_f32_16x16x32_bf16 v[220:223], v[60:63], v[12:15], v[220:223]
    v_add_u32 v79, 40960, v79
    ds_read_b64_tr_b16 v[60:61], v79
    ds_read_b64_tr_b16 v[62:63], v79 offset:1024
    s_waitcnt lgkmcnt(14)
    v_mfma_f32_16x16x32_bf16 v[224:227], v[64:67], v[0:3], v[224:227]
    v_mfma_f32_16x16x32_bf16 v[228:231], v[64:67], v[4:7], v[228:231]
    v_mfma_f32_16x16x32_bf16 v[232:235], v[64:67], v[8:11], v[232:235]
    v_mfma_f32_16x16x32_bf16 v[236:239], v[64:67], v[12:15], v[236:239]
    v_add_u32 v80, 40960, v80
    ds_read_b64_tr_b16 v[64:65], v80
    ds_read_b64_tr_b16 v[66:67], v80 offset:1024
    s_waitcnt lgkmcnt(14)
    v_mfma_f32_16x16x32_bf16 v[240:243], v[68:71], v[0:3], v[240:243]
    v_mfma_f32_16x16x32_bf16 v[244:247], v[68:71], v[4:7], v[244:247]
    v_mfma_f32_16x16x32_bf16 v[248:251], v[68:71], v[8:11], v[248:251]
    v_mfma_f32_16x16x32_bf16 v[252:255], v[68:71], v[12:15], v[252:255]
    v_add_u32 v81, 40960, v81
    ds_read_b64_tr_b16 v[68:69], v81
    ds_read_b64_tr_b16 v[70:71], v81 offset:1024
    s_waitcnt lgkmcnt(14)
    v_mfma_f32_16x16x32_bf16 v[96:99], v[32:35], v[16:19], v[96:99]
    v_mfma_f32_16x16x32_bf16 v[100:103], v[32:35], v[20:23], v[100:103]
    v_mfma_f32_16x16x32_bf16 v[104:107], v[32:35], v[24:27], v[104:107]
    v_mfma_f32_16x16x32_bf16 v[108:111], v[32:35], v[28:31], v[108:111]
    s_waitcnt lgkmcnt(14)
    v_mfma_f32_16x16x32_bf16 v[112:115], v[36:39], v[16:19], v[112:115]
    v_mfma_f32_16x16x32_bf16 v[116:119], v[36:39], v[20:23], v[116:119]
    v_mfma_f32_16x16x32_bf16 v[120:123], v[36:39], v[24:27], v[120:123]
    v_mfma_f32_16x16x32_bf16 v[124:127], v[36:39], v[28:31], v[124:127]
    s_waitcnt lgkmcnt(14)
    v_mfma_f32_16x16x32_bf16 v[128:131], v[40:43], v[16:19], v[128:131]
    v_mfma_f32_16x16x32_bf16 v[132:135], v[40:43], v[20:23], v[132:135]
    v_mfma_f32_16x16x32_bf16 v[136:139], v[40:43], v[24:27], v[136:139]
    v_mfma_f32_16x16x32_bf16 v[140:143], v[40:43], v[28:31], v[140:143]
    s_waitcnt lgkmcnt(12)
    v_mfma_f32_16x16x32_bf16 v[144:147], v[44:47], v[16:19], v[144:147]
    v_mfma_f32_16x16x32_bf16 v[148:151], v[44:47], v[20:23], v[148:151]
    v_mfma_f32_16x16x32_bf16 v[152:155], v[44:47], v[24:27], v[152:155]
    v_mfma_f32_16x16x32_bf16 v[156:159], v[44:47], v[28:31], v[156:159]
    s_waitcnt lgkmcnt(10)
    v_mfma_f32_16x16x32_bf16 v[160:163], v[48:51], v[16:19], v[160:163]
    v_mfma_f32_16x16x32_bf16 v[164:167], v[48:51], v[20:23], v[164:167]
    v_mfma_f32_16x16x32_bf16 v[168:171], v[48:51], v[24:27], v[168:171]
    v_mfma_f32_16x16x32_bf16 v[172:175], v[48:51], v[28:31], v[172:175]
    s_waitcnt lgkmcnt(8)
    v_mfma_f32_16x16x32_bf16 v[176:179], v[52:55], v[16:19], v[176:179]
    v_mfma_f32_16x16x32_bf16 v[180:183], v[52:55], v[20:23], v[180:183]
    v_mfma_f32_16x16x32_bf16 v[184:187], v[52:55], v[24:27], v[184:187]
    v_mfma_f32_16x16x32_bf16 v[188:191], v[52:55], v[28:31], v[188:191]
    s_waitcnt lgkmcnt(6)
    v_mfma_f32_16x16x32_bf16 v[192:195], v[56:59], v[16:19], v[192:195]
    v_mfma_f32_16x16x32_bf16 v[196:199], v[56:59], v[20:23], v[196:199]
    v_mfma_f32_16x16x32_bf16 v[200:203], v[56:59], v[24:27], v[200:203]
    v_mfma_f32_16x16x32_bf16 v[204:207], v[56:59], v[28:31], v[204:207]
    s_waitcnt lgkmcnt(4)
    v_mfma_f32_16x16x32_bf16 v[208:211], v[60:63], v[16:19], v[208:211]
    v_mfma_f32_16x16x32_bf16 v[212:215], v[60:63], v[20:23], v[212:215]
    v_mfma_f32_16x16x32_bf16 v[216:219], v[60:63], v[24:27], v[216:219]
    v_mfma_f32_16x16x32_bf16 v[220:223], v[60:63], v[28:31], v[220:223]
    s_waitcnt lgkmcnt(2)
    v_mfma_f32_16x16x32_bf16 v[224:227], v[64:67], v[16:19], v[224:227]
    v_mfma_f32_16x16x32_bf16 v[228:231], v[64:67], v[20:23], v[228:231]
    v_mfma_f32_16x16x32_bf16 v[232:235], v[64:67], v[24:27], v[232:235]
    v_mfma_f32_16x16x32_bf16 v[236:239], v[64:67], v[28:31], v[236:239]
    s_waitcnt lgkmcnt(0)
    v_mfma_f32_16x16x32_bf16 v[240:243], v[68:71], v[16:19], v[240:243]
    v_mfma_f32_16x16x32_bf16 v[244:247], v[68:71], v[20:23], v[244:247]
    v_mfma_f32_16x16x32_bf16 v[248:251], v[68:71], v[24:27], v[248:251]
    v_mfma_f32_16x16x32_bf16 v[252:255], v[68:71], v[28:31], v[252:255]
    s_nop 15
    v_mbcnt_lo_u32_b32 v2, -1, 0
    v_mbcnt_hi_u32_b32 v2, -1, v2
    v_lshrrev_b32 v3, 4, v2
    v_and_b32 v4, 15, v2
    s_lshl_b32 s44, s38, 8
    s_lshl_b32 s45, s36, 6
    s_add_u32 s44, s44, s45
    v_add_u32 v5, s44, v4
    s_barrier
    s_lshl_b32 s44, s36, 6
    v_add_u32 v7, s44, v4
    s_cmp_eq_u32 s37, 1
    s_cbranch_scc1 L_g1_ep_wn1_5
    v_mul_u32_u24 v6, 192, v7
    v_lshl_add_u32 v6, v3, 3, v6
    v_cvt_pk_bf16_f32 v8, v96, v97
    v_cvt_pk_bf16_f32 v9, v98, v99
    ds_write_b64 v6, v[8:9] offset:0
    v_cvt_pk_bf16_f32 v8, v112, v113
    v_cvt_pk_bf16_f32 v9, v114, v115
    ds_write_b64 v6, v[8:9] offset:32
    v_cvt_pk_bf16_f32 v8, v128, v129
    v_cvt_pk_bf16_f32 v9, v130, v131
    ds_write_b64 v6, v[8:9] offset:64
    v_cvt_pk_bf16_f32 v8, v144, v145
    v_cvt_pk_bf16_f32 v9, v146, v147
    ds_write_b64 v6, v[8:9] offset:96
    v_cvt_pk_bf16_f32 v8, v160, v161
    v_cvt_pk_bf16_f32 v9, v162, v163
    ds_write_b64 v6, v[8:9] offset:128
    v_cvt_pk_bf16_f32 v8, v176, v177
    v_cvt_pk_bf16_f32 v9, v178, v179
    ds_write_b64 v6, v[8:9] offset:160
    v_cvt_pk_bf16_f32 v8, v100, v101
    v_cvt_pk_bf16_f32 v9, v102, v103
    ds_write_b64 v6, v[8:9] offset:3072
    v_cvt_pk_bf16_f32 v8, v116, v117
    v_cvt_pk_bf16_f32 v9, v118, v119
    ds_write_b64 v6, v[8:9] offset:3104
    v_cvt_pk_bf16_f32 v8, v132, v133
    v_cvt_pk_bf16_f32 v9, v134, v135
    ds_write_b64 v6, v[8:9] offset:3136
    v_cvt_pk_bf16_f32 v8, v148, v149
    v_cvt_pk_bf16_f32 v9, v150, v151
    ds_write_b64 v6, v[8:9] offset:3168
    v_cvt_pk_bf16_f32 v8, v164, v165
    v_cvt_pk_bf16_f32 v9, v166, v167
    ds_write_b64 v6, v[8:9] offset:3200
    v_cvt_pk_bf16_f32 v8, v180, v181
    v_cvt_pk_bf16_f32 v9, v182, v183
    ds_write_b64 v6, v[8:9] offset:3232
    v_cvt_pk_bf16_f32 v8, v104, v105
    v_cvt_pk_bf16_f32 v9, v106, v107
    ds_write_b64 v6, v[8:9] offset:6144
    v_cvt_pk_bf16_f32 v8, v120, v121
    v_cvt_pk_bf16_f32 v9, v122, v123
    ds_write_b64 v6, v[8:9] offset:6176
    v_cvt_pk_bf16_f32 v8, v136, v137
    v_cvt_pk_bf16_f32 v9, v138, v139
    ds_write_b64 v6, v[8:9] offset:6208
    v_cvt_pk_bf16_f32 v8, v152, v153
    v_cvt_pk_bf16_f32 v9, v154, v155
    ds_write_b64 v6, v[8:9] offset:6240
    v_cvt_pk_bf16_f32 v8, v168, v169
    v_cvt_pk_bf16_f32 v9, v170, v171
    ds_write_b64 v6, v[8:9] offset:6272
    v_cvt_pk_bf16_f32 v8, v184, v185
    v_cvt_pk_bf16_f32 v9, v186, v187
    ds_write_b64 v6, v[8:9] offset:6304
    v_cvt_pk_bf16_f32 v8, v108, v109
    v_cvt_pk_bf16_f32 v9, v110, v111
    ds_write_b64 v6, v[8:9] offset:9216
    v_cvt_pk_bf16_f32 v8, v124, v125
    v_cvt_pk_bf16_f32 v9, v126, v127
    ds_write_b64 v6, v[8:9] offset:9248
    v_cvt_pk_bf16_f32 v8, v140, v141
    v_cvt_pk_bf16_f32 v9, v142, v143
    ds_write_b64 v6, v[8:9] offset:9280
    v_cvt_pk_bf16_f32 v8, v156, v157
    v_cvt_pk_bf16_f32 v9, v158, v159
    ds_write_b64 v6, v[8:9] offset:9312
    v_cvt_pk_bf16_f32 v8, v172, v173
    v_cvt_pk_bf16_f32 v9, v174, v175
    ds_write_b64 v6, v[8:9] offset:9344
    v_cvt_pk_bf16_f32 v8, v188, v189
    v_cvt_pk_bf16_f32 v9, v190, v191
    ds_write_b64 v6, v[8:9] offset:9376
    v_mul_u32_u24 v6, 224, v7
    v_lshl_add_u32 v6, v3, 3, v6
    v_cvt_pk_bf16_f32 v16, v192, v192
    v_cvt_pk_bf16_f32 v17, v193, v193
    v_cvt_pk_bf16_f32 v18, v194, v194
    v_cvt_pk_bf16_f32 v19, v195, v195
    v_lshlrev_b32 v16, 16, v16
    v_lshlrev_b32 v17, 16, v17
    v_lshlrev_b32 v18, 16, v18
    v_lshlrev_b32 v19, 16, v19
    v_mul_f32 v20, 0xbfb8aa3b, v16
    v_mul_f32 v21, 0xbfb8aa3b, v17
    v_mul_f32 v22, 0xbfb8aa3b, v18
    v_mul_f32 v23, 0xbfb8aa3b, v19
    v_exp_f32 v20, v20
    v_exp_f32 v21, v21
    v_exp_f32 v22, v22
    v_exp_f32 v23, v23
    v_add_f32 v20, 1.0, v20
    v_add_f32 v21, 1.0, v21
    v_add_f32 v22, 1.0, v22
    v_add_f32 v23, 1.0, v23
    v_rcp_f32 v20, v20
    v_rcp_f32 v21, v21
    v_rcp_f32 v22, v22
    v_rcp_f32 v23, v23
    v_mul_f32 v16, v16, v20
    v_mul_f32 v17, v17, v21
    v_mul_f32 v18, v18, v22
    v_mul_f32 v19, v19, v23
    v_cvt_pk_bf16_f32 v16, v16, v16
    v_cvt_pk_bf16_f32 v17, v17, v17
    v_cvt_pk_bf16_f32 v18, v18, v18
    v_cvt_pk_bf16_f32 v19, v19, v19
    v_lshlrev_b32 v16, 16, v16
    v_lshlrev_b32 v17, 16, v17
    v_lshlrev_b32 v18, 16, v18
    v_lshlrev_b32 v19, 16, v19
    v_cvt_pk_bf16_f32 v24, v224, v224
    v_cvt_pk_bf16_f32 v25, v225, v225
    v_cvt_pk_bf16_f32 v26, v226, v226
    v_cvt_pk_bf16_f32 v27, v227, v227
    v_lshlrev_b32 v24, 16, v24
    v_lshlrev_b32 v25, 16, v25
    v_lshlrev_b32 v26, 16, v26
    v_lshlrev_b32 v27, 16, v27
    v_mul_f32 v12, v16, v24
    v_mul_f32 v13, v17, v25
    v_mul_f32 v14, v18, v26
    v_mul_f32 v15, v19, v27
    v_cvt_pk_bf16_f32 v8, v12, v13
    v_cvt_pk_bf16_f32 v9, v14, v15
    ds_write_b64 v6, v[8:9] offset:49152
    v_cvt_pk_bf16_f32 v16, v208, v208
    v_cvt_pk_bf16_f32 v17, v209, v209
    v_cvt_pk_bf16_f32 v18, v210, v210
    v_cvt_pk_bf16_f32 v19, v211, v211
    v_lshlrev_b32 v16, 16, v16
    v_lshlrev_b32 v17, 16, v17
    v_lshlrev_b32 v18, 16, v18
    v_lshlrev_b32 v19, 16, v19
    v_mul_f32 v20, 0xbfb8aa3b, v16
    v_mul_f32 v21, 0xbfb8aa3b, v17
    v_mul_f32 v22, 0xbfb8aa3b, v18
    v_mul_f32 v23, 0xbfb8aa3b, v19
    v_exp_f32 v20, v20
    v_exp_f32 v21, v21
    v_exp_f32 v22, v22
    v_exp_f32 v23, v23
    v_add_f32 v20, 1.0, v20
    v_add_f32 v21, 1.0, v21
    v_add_f32 v22, 1.0, v22
    v_add_f32 v23, 1.0, v23
    v_rcp_f32 v20, v20
    v_rcp_f32 v21, v21
    v_rcp_f32 v22, v22
    v_rcp_f32 v23, v23
    v_mul_f32 v16, v16, v20
    v_mul_f32 v17, v17, v21
    v_mul_f32 v18, v18, v22
    v_mul_f32 v19, v19, v23
    v_cvt_pk_bf16_f32 v16, v16, v16
    v_cvt_pk_bf16_f32 v17, v17, v17
    v_cvt_pk_bf16_f32 v18, v18, v18
    v_cvt_pk_bf16_f32 v19, v19, v19
    v_lshlrev_b32 v16, 16, v16
    v_lshlrev_b32 v17, 16, v17
    v_lshlrev_b32 v18, 16, v18
    v_lshlrev_b32 v19, 16, v19
    v_cvt_pk_bf16_f32 v24, v240, v240
    v_cvt_pk_bf16_f32 v25, v241, v241
    v_cvt_pk_bf16_f32 v26, v242, v242
    v_cvt_pk_bf16_f32 v27, v243, v243
    v_lshlrev_b32 v24, 16, v24
    v_lshlrev_b32 v25, 16, v25
    v_lshlrev_b32 v26, 16, v26
    v_lshlrev_b32 v27, 16, v27
    v_mul_f32 v12, v16, v24
    v_mul_f32 v13, v17, v25
    v_mul_f32 v14, v18, v26
    v_mul_f32 v15, v19, v27
    v_cvt_pk_bf16_f32 v8, v12, v13
    v_cvt_pk_bf16_f32 v9, v14, v15
    ds_write_b64 v6, v[8:9] offset:49184
    v_cvt_pk_bf16_f32 v16, v196, v196
    v_cvt_pk_bf16_f32 v17, v197, v197
    v_cvt_pk_bf16_f32 v18, v198, v198
    v_cvt_pk_bf16_f32 v19, v199, v199
    v_lshlrev_b32 v16, 16, v16
    v_lshlrev_b32 v17, 16, v17
    v_lshlrev_b32 v18, 16, v18
    v_lshlrev_b32 v19, 16, v19
    v_mul_f32 v20, 0xbfb8aa3b, v16
    v_mul_f32 v21, 0xbfb8aa3b, v17
    v_mul_f32 v22, 0xbfb8aa3b, v18
    v_mul_f32 v23, 0xbfb8aa3b, v19
    v_exp_f32 v20, v20
    v_exp_f32 v21, v21
    v_exp_f32 v22, v22
    v_exp_f32 v23, v23
    v_add_f32 v20, 1.0, v20
    v_add_f32 v21, 1.0, v21
    v_add_f32 v22, 1.0, v22
    v_add_f32 v23, 1.0, v23
    v_rcp_f32 v20, v20
    v_rcp_f32 v21, v21
    v_rcp_f32 v22, v22
    v_rcp_f32 v23, v23
    v_mul_f32 v16, v16, v20
    v_mul_f32 v17, v17, v21
    v_mul_f32 v18, v18, v22
    v_mul_f32 v19, v19, v23
    v_cvt_pk_bf16_f32 v16, v16, v16
    v_cvt_pk_bf16_f32 v17, v17, v17
    v_cvt_pk_bf16_f32 v18, v18, v18
    v_cvt_pk_bf16_f32 v19, v19, v19
    v_lshlrev_b32 v16, 16, v16
    v_lshlrev_b32 v17, 16, v17
    v_lshlrev_b32 v18, 16, v18
    v_lshlrev_b32 v19, 16, v19
    v_cvt_pk_bf16_f32 v24, v228, v228
    v_cvt_pk_bf16_f32 v25, v229, v229
    v_cvt_pk_bf16_f32 v26, v230, v230
    v_cvt_pk_bf16_f32 v27, v231, v231
    v_lshlrev_b32 v24, 16, v24
    v_lshlrev_b32 v25, 16, v25
    v_lshlrev_b32 v26, 16, v26
    v_lshlrev_b32 v27, 16, v27
    v_mul_f32 v12, v16, v24
    v_mul_f32 v13, v17, v25
    v_mul_f32 v14, v18, v26
    v_mul_f32 v15, v19, v27
    v_cvt_pk_bf16_f32 v8, v12, v13
    v_cvt_pk_bf16_f32 v9, v14, v15
    ds_write_b64 v6, v[8:9] offset:52736
    v_cvt_pk_bf16_f32 v16, v212, v212
    v_cvt_pk_bf16_f32 v17, v213, v213
    v_cvt_pk_bf16_f32 v18, v214, v214
    v_cvt_pk_bf16_f32 v19, v215, v215
    v_lshlrev_b32 v16, 16, v16
    v_lshlrev_b32 v17, 16, v17
    v_lshlrev_b32 v18, 16, v18
    v_lshlrev_b32 v19, 16, v19
    v_mul_f32 v20, 0xbfb8aa3b, v16
    v_mul_f32 v21, 0xbfb8aa3b, v17
    v_mul_f32 v22, 0xbfb8aa3b, v18
    v_mul_f32 v23, 0xbfb8aa3b, v19
    v_exp_f32 v20, v20
    v_exp_f32 v21, v21
    v_exp_f32 v22, v22
    v_exp_f32 v23, v23
    v_add_f32 v20, 1.0, v20
    v_add_f32 v21, 1.0, v21
    v_add_f32 v22, 1.0, v22
    v_add_f32 v23, 1.0, v23
    v_rcp_f32 v20, v20
    v_rcp_f32 v21, v21
    v_rcp_f32 v22, v22
    v_rcp_f32 v23, v23
    v_mul_f32 v16, v16, v20
    v_mul_f32 v17, v17, v21
    v_mul_f32 v18, v18, v22
    v_mul_f32 v19, v19, v23
    v_cvt_pk_bf16_f32 v16, v16, v16
    v_cvt_pk_bf16_f32 v17, v17, v17
    v_cvt_pk_bf16_f32 v18, v18, v18
    v_cvt_pk_bf16_f32 v19, v19, v19
    v_lshlrev_b32 v16, 16, v16
    v_lshlrev_b32 v17, 16, v17
    v_lshlrev_b32 v18, 16, v18
    v_lshlrev_b32 v19, 16, v19
    v_cvt_pk_bf16_f32 v24, v244, v244
    v_cvt_pk_bf16_f32 v25, v245, v245
    v_cvt_pk_bf16_f32 v26, v246, v246
    v_cvt_pk_bf16_f32 v27, v247, v247
    v_lshlrev_b32 v24, 16, v24
    v_lshlrev_b32 v25, 16, v25
    v_lshlrev_b32 v26, 16, v26
    v_lshlrev_b32 v27, 16, v27
    v_mul_f32 v12, v16, v24
    v_mul_f32 v13, v17, v25
    v_mul_f32 v14, v18, v26
    v_mul_f32 v15, v19, v27
    v_cvt_pk_bf16_f32 v8, v12, v13
    v_cvt_pk_bf16_f32 v9, v14, v15
    ds_write_b64 v6, v[8:9] offset:52768
    v_cvt_pk_bf16_f32 v16, v200, v200
    v_cvt_pk_bf16_f32 v17, v201, v201
    v_cvt_pk_bf16_f32 v18, v202, v202
    v_cvt_pk_bf16_f32 v19, v203, v203
    v_lshlrev_b32 v16, 16, v16
    v_lshlrev_b32 v17, 16, v17
    v_lshlrev_b32 v18, 16, v18
    v_lshlrev_b32 v19, 16, v19
    v_mul_f32 v20, 0xbfb8aa3b, v16
    v_mul_f32 v21, 0xbfb8aa3b, v17
    v_mul_f32 v22, 0xbfb8aa3b, v18
    v_mul_f32 v23, 0xbfb8aa3b, v19
    v_exp_f32 v20, v20
    v_exp_f32 v21, v21
    v_exp_f32 v22, v22
    v_exp_f32 v23, v23
    v_add_f32 v20, 1.0, v20
    v_add_f32 v21, 1.0, v21
    v_add_f32 v22, 1.0, v22
    v_add_f32 v23, 1.0, v23
    v_rcp_f32 v20, v20
    v_rcp_f32 v21, v21
    v_rcp_f32 v22, v22
    v_rcp_f32 v23, v23
    v_mul_f32 v16, v16, v20
    v_mul_f32 v17, v17, v21
    v_mul_f32 v18, v18, v22
    v_mul_f32 v19, v19, v23
    v_cvt_pk_bf16_f32 v16, v16, v16
    v_cvt_pk_bf16_f32 v17, v17, v17
    v_cvt_pk_bf16_f32 v18, v18, v18
    v_cvt_pk_bf16_f32 v19, v19, v19
    v_lshlrev_b32 v16, 16, v16
    v_lshlrev_b32 v17, 16, v17
    v_lshlrev_b32 v18, 16, v18
    v_lshlrev_b32 v19, 16, v19
    v_cvt_pk_bf16_f32 v24, v232, v232
    v_cvt_pk_bf16_f32 v25, v233, v233
    v_cvt_pk_bf16_f32 v26, v234, v234
    v_cvt_pk_bf16_f32 v27, v235, v235
    v_lshlrev_b32 v24, 16, v24
    v_lshlrev_b32 v25, 16, v25
    v_lshlrev_b32 v26, 16, v26
    v_lshlrev_b32 v27, 16, v27
    v_mul_f32 v12, v16, v24
    v_mul_f32 v13, v17, v25
    v_mul_f32 v14, v18, v26
    v_mul_f32 v15, v19, v27
    v_cvt_pk_bf16_f32 v8, v12, v13
    v_cvt_pk_bf16_f32 v9, v14, v15
    ds_write_b64 v6, v[8:9] offset:56320
    v_cvt_pk_bf16_f32 v16, v216, v216
    v_cvt_pk_bf16_f32 v17, v217, v217
    v_cvt_pk_bf16_f32 v18, v218, v218
    v_cvt_pk_bf16_f32 v19, v219, v219
    v_lshlrev_b32 v16, 16, v16
    v_lshlrev_b32 v17, 16, v17
    v_lshlrev_b32 v18, 16, v18
    v_lshlrev_b32 v19, 16, v19
    v_mul_f32 v20, 0xbfb8aa3b, v16
    v_mul_f32 v21, 0xbfb8aa3b, v17
    v_mul_f32 v22, 0xbfb8aa3b, v18
    v_mul_f32 v23, 0xbfb8aa3b, v19
    v_exp_f32 v20, v20
    v_exp_f32 v21, v21
    v_exp_f32 v22, v22
    v_exp_f32 v23, v23
    v_add_f32 v20, 1.0, v20
    v_add_f32 v21, 1.0, v21
    v_add_f32 v22, 1.0, v22
    v_add_f32 v23, 1.0, v23
    v_rcp_f32 v20, v20
    v_rcp_f32 v21, v21
    v_rcp_f32 v22, v22
    v_rcp_f32 v23, v23
    v_mul_f32 v16, v16, v20
    v_mul_f32 v17, v17, v21
    v_mul_f32 v18, v18, v22
    v_mul_f32 v19, v19, v23
    v_cvt_pk_bf16_f32 v16, v16, v16
    v_cvt_pk_bf16_f32 v17, v17, v17
    v_cvt_pk_bf16_f32 v18, v18, v18
    v_cvt_pk_bf16_f32 v19, v19, v19
    v_lshlrev_b32 v16, 16, v16
    v_lshlrev_b32 v17, 16, v17
    v_lshlrev_b32 v18, 16, v18
    v_lshlrev_b32 v19, 16, v19
    v_cvt_pk_bf16_f32 v24, v248, v248
    v_cvt_pk_bf16_f32 v25, v249, v249
    v_cvt_pk_bf16_f32 v26, v250, v250
    v_cvt_pk_bf16_f32 v27, v251, v251
    v_lshlrev_b32 v24, 16, v24
    v_lshlrev_b32 v25, 16, v25
    v_lshlrev_b32 v26, 16, v26
    v_lshlrev_b32 v27, 16, v27
    v_mul_f32 v12, v16, v24
    v_mul_f32 v13, v17, v25
    v_mul_f32 v14, v18, v26
    v_mul_f32 v15, v19, v27
    v_cvt_pk_bf16_f32 v8, v12, v13
    v_cvt_pk_bf16_f32 v9, v14, v15
    ds_write_b64 v6, v[8:9] offset:56352
    v_cvt_pk_bf16_f32 v16, v204, v204
    v_cvt_pk_bf16_f32 v17, v205, v205
    v_cvt_pk_bf16_f32 v18, v206, v206
    v_cvt_pk_bf16_f32 v19, v207, v207
    v_lshlrev_b32 v16, 16, v16
    v_lshlrev_b32 v17, 16, v17
    v_lshlrev_b32 v18, 16, v18
    v_lshlrev_b32 v19, 16, v19
    v_mul_f32 v20, 0xbfb8aa3b, v16
    v_mul_f32 v21, 0xbfb8aa3b, v17
    v_mul_f32 v22, 0xbfb8aa3b, v18
    v_mul_f32 v23, 0xbfb8aa3b, v19
    v_exp_f32 v20, v20
    v_exp_f32 v21, v21
    v_exp_f32 v22, v22
    v_exp_f32 v23, v23
    v_add_f32 v20, 1.0, v20
    v_add_f32 v21, 1.0, v21
    v_add_f32 v22, 1.0, v22
    v_add_f32 v23, 1.0, v23
    v_rcp_f32 v20, v20
    v_rcp_f32 v21, v21
    v_rcp_f32 v22, v22
    v_rcp_f32 v23, v23
    v_mul_f32 v16, v16, v20
    v_mul_f32 v17, v17, v21
    v_mul_f32 v18, v18, v22
    v_mul_f32 v19, v19, v23
    v_cvt_pk_bf16_f32 v16, v16, v16
    v_cvt_pk_bf16_f32 v17, v17, v17
    v_cvt_pk_bf16_f32 v18, v18, v18
    v_cvt_pk_bf16_f32 v19, v19, v19
    v_lshlrev_b32 v16, 16, v16
    v_lshlrev_b32 v17, 16, v17
    v_lshlrev_b32 v18, 16, v18
    v_lshlrev_b32 v19, 16, v19
    v_cvt_pk_bf16_f32 v24, v236, v236
    v_cvt_pk_bf16_f32 v25, v237, v237
    v_cvt_pk_bf16_f32 v26, v238, v238
    v_cvt_pk_bf16_f32 v27, v239, v239
    v_lshlrev_b32 v24, 16, v24
    v_lshlrev_b32 v25, 16, v25
    v_lshlrev_b32 v26, 16, v26
    v_lshlrev_b32 v27, 16, v27
    v_mul_f32 v12, v16, v24
    v_mul_f32 v13, v17, v25
    v_mul_f32 v14, v18, v26
    v_mul_f32 v15, v19, v27
    v_cvt_pk_bf16_f32 v8, v12, v13
    v_cvt_pk_bf16_f32 v9, v14, v15
    ds_write_b64 v6, v[8:9] offset:59904
    v_cvt_pk_bf16_f32 v16, v220, v220
    v_cvt_pk_bf16_f32 v17, v221, v221
    v_cvt_pk_bf16_f32 v18, v222, v222
    v_cvt_pk_bf16_f32 v19, v223, v223
    v_lshlrev_b32 v16, 16, v16
    v_lshlrev_b32 v17, 16, v17
    v_lshlrev_b32 v18, 16, v18
    v_lshlrev_b32 v19, 16, v19
    v_mul_f32 v20, 0xbfb8aa3b, v16
    v_mul_f32 v21, 0xbfb8aa3b, v17
    v_mul_f32 v22, 0xbfb8aa3b, v18
    v_mul_f32 v23, 0xbfb8aa3b, v19
    v_exp_f32 v20, v20
    v_exp_f32 v21, v21
    v_exp_f32 v22, v22
    v_exp_f32 v23, v23
    v_add_f32 v20, 1.0, v20
    v_add_f32 v21, 1.0, v21
    v_add_f32 v22, 1.0, v22
    v_add_f32 v23, 1.0, v23
    v_rcp_f32 v20, v20
    v_rcp_f32 v21, v21
    v_rcp_f32 v22, v22
    v_rcp_f32 v23, v23
    v_mul_f32 v16, v16, v20
    v_mul_f32 v17, v17, v21
    v_mul_f32 v18, v18, v22
    v_mul_f32 v19, v19, v23
    v_cvt_pk_bf16_f32 v16, v16, v16
    v_cvt_pk_bf16_f32 v17, v17, v17
    v_cvt_pk_bf16_f32 v18, v18, v18
    v_cvt_pk_bf16_f32 v19, v19, v19
    v_lshlrev_b32 v16, 16, v16
    v_lshlrev_b32 v17, 16, v17
    v_lshlrev_b32 v18, 16, v18
    v_lshlrev_b32 v19, 16, v19
    v_cvt_pk_bf16_f32 v24, v252, v252
    v_cvt_pk_bf16_f32 v25, v253, v253
    v_cvt_pk_bf16_f32 v26, v254, v254
    v_cvt_pk_bf16_f32 v27, v255, v255
    v_lshlrev_b32 v24, 16, v24
    v_lshlrev_b32 v25, 16, v25
    v_lshlrev_b32 v26, 16, v26
    v_lshlrev_b32 v27, 16, v27
    v_mul_f32 v12, v16, v24
    v_mul_f32 v13, v17, v25
    v_mul_f32 v14, v18, v26
    v_mul_f32 v15, v19, v27
    v_cvt_pk_bf16_f32 v8, v12, v13
    v_cvt_pk_bf16_f32 v9, v14, v15
    ds_write_b64 v6, v[8:9] offset:59936
    s_branch L_g1_ep_st_6
L_g1_ep_wn1_5:
    v_mul_u32_u24 v6, 224, v7
    v_lshl_add_u32 v6, v3, 3, v6
    v_cvt_pk_bf16_f32 v16, v96, v96
    v_cvt_pk_bf16_f32 v17, v97, v97
    v_cvt_pk_bf16_f32 v18, v98, v98
    v_cvt_pk_bf16_f32 v19, v99, v99
    v_lshlrev_b32 v16, 16, v16
    v_lshlrev_b32 v17, 16, v17
    v_lshlrev_b32 v18, 16, v18
    v_lshlrev_b32 v19, 16, v19
    v_mul_f32 v20, 0xbfb8aa3b, v16
    v_mul_f32 v21, 0xbfb8aa3b, v17
    v_mul_f32 v22, 0xbfb8aa3b, v18
    v_mul_f32 v23, 0xbfb8aa3b, v19
    v_exp_f32 v20, v20
    v_exp_f32 v21, v21
    v_exp_f32 v22, v22
    v_exp_f32 v23, v23
    v_add_f32 v20, 1.0, v20
    v_add_f32 v21, 1.0, v21
    v_add_f32 v22, 1.0, v22
    v_add_f32 v23, 1.0, v23
    v_rcp_f32 v20, v20
    v_rcp_f32 v21, v21
    v_rcp_f32 v22, v22
    v_rcp_f32 v23, v23
    v_mul_f32 v16, v16, v20
    v_mul_f32 v17, v17, v21
    v_mul_f32 v18, v18, v22
    v_mul_f32 v19, v19, v23
    v_cvt_pk_bf16_f32 v16, v16, v16
    v_cvt_pk_bf16_f32 v17, v17, v17
    v_cvt_pk_bf16_f32 v18, v18, v18
    v_cvt_pk_bf16_f32 v19, v19, v19
    v_lshlrev_b32 v16, 16, v16
    v_lshlrev_b32 v17, 16, v17
    v_lshlrev_b32 v18, 16, v18
    v_lshlrev_b32 v19, 16, v19
    v_cvt_pk_bf16_f32 v24, v176, v176
    v_cvt_pk_bf16_f32 v25, v177, v177
    v_cvt_pk_bf16_f32 v26, v178, v178
    v_cvt_pk_bf16_f32 v27, v179, v179
    v_lshlrev_b32 v24, 16, v24
    v_lshlrev_b32 v25, 16, v25
    v_lshlrev_b32 v26, 16, v26
    v_lshlrev_b32 v27, 16, v27
    v_mul_f32 v12, v16, v24
    v_mul_f32 v13, v17, v25
    v_mul_f32 v14, v18, v26
    v_mul_f32 v15, v19, v27
    v_cvt_pk_bf16_f32 v8, v12, v13
    v_cvt_pk_bf16_f32 v9, v14, v15
    ds_write_b64 v6, v[8:9] offset:49216
    v_cvt_pk_bf16_f32 v16, v112, v112
    v_cvt_pk_bf16_f32 v17, v113, v113
    v_cvt_pk_bf16_f32 v18, v114, v114
    v_cvt_pk_bf16_f32 v19, v115, v115
    v_lshlrev_b32 v16, 16, v16
    v_lshlrev_b32 v17, 16, v17
    v_lshlrev_b32 v18, 16, v18
    v_lshlrev_b32 v19, 16, v19
    v_mul_f32 v20, 0xbfb8aa3b, v16
    v_mul_f32 v21, 0xbfb8aa3b, v17
    v_mul_f32 v22, 0xbfb8aa3b, v18
    v_mul_f32 v23, 0xbfb8aa3b, v19
    v_exp_f32 v20, v20
    v_exp_f32 v21, v21
    v_exp_f32 v22, v22
    v_exp_f32 v23, v23
    v_add_f32 v20, 1.0, v20
    v_add_f32 v21, 1.0, v21
    v_add_f32 v22, 1.0, v22
    v_add_f32 v23, 1.0, v23
    v_rcp_f32 v20, v20
    v_rcp_f32 v21, v21
    v_rcp_f32 v22, v22
    v_rcp_f32 v23, v23
    v_mul_f32 v16, v16, v20
    v_mul_f32 v17, v17, v21
    v_mul_f32 v18, v18, v22
    v_mul_f32 v19, v19, v23
    v_cvt_pk_bf16_f32 v16, v16, v16
    v_cvt_pk_bf16_f32 v17, v17, v17
    v_cvt_pk_bf16_f32 v18, v18, v18
    v_cvt_pk_bf16_f32 v19, v19, v19
    v_lshlrev_b32 v16, 16, v16
    v_lshlrev_b32 v17, 16, v17
    v_lshlrev_b32 v18, 16, v18
    v_lshlrev_b32 v19, 16, v19
    v_cvt_pk_bf16_f32 v24, v192, v192
    v_cvt_pk_bf16_f32 v25, v193, v193
    v_cvt_pk_bf16_f32 v26, v194, v194
    v_cvt_pk_bf16_f32 v27, v195, v195
    v_lshlrev_b32 v24, 16, v24
    v_lshlrev_b32 v25, 16, v25
    v_lshlrev_b32 v26, 16, v26
    v_lshlrev_b32 v27, 16, v27
    v_mul_f32 v12, v16, v24
    v_mul_f32 v13, v17, v25
    v_mul_f32 v14, v18, v26
    v_mul_f32 v15, v19, v27
    v_cvt_pk_bf16_f32 v8, v12, v13
    v_cvt_pk_bf16_f32 v9, v14, v15
    ds_write_b64 v6, v[8:9] offset:49248
    v_cvt_pk_bf16_f32 v16, v128, v128
    v_cvt_pk_bf16_f32 v17, v129, v129
    v_cvt_pk_bf16_f32 v18, v130, v130
    v_cvt_pk_bf16_f32 v19, v131, v131
    v_lshlrev_b32 v16, 16, v16
    v_lshlrev_b32 v17, 16, v17
    v_lshlrev_b32 v18, 16, v18
    v_lshlrev_b32 v19, 16, v19
    v_mul_f32 v20, 0xbfb8aa3b, v16
    v_mul_f32 v21, 0xbfb8aa3b, v17
    v_mul_f32 v22, 0xbfb8aa3b, v18
    v_mul_f32 v23, 0xbfb8aa3b, v19
    v_exp_f32 v20, v20
    v_exp_f32 v21, v21
    v_exp_f32 v22, v22
    v_exp_f32 v23, v23
    v_add_f32 v20, 1.0, v20
    v_add_f32 v21, 1.0, v21
    v_add_f32 v22, 1.0, v22
    v_add_f32 v23, 1.0, v23
    v_rcp_f32 v20, v20
    v_rcp_f32 v21, v21
    v_rcp_f32 v22, v22
    v_rcp_f32 v23, v23
    v_mul_f32 v16, v16, v20
    v_mul_f32 v17, v17, v21
    v_mul_f32 v18, v18, v22
    v_mul_f32 v19, v19, v23
    v_cvt_pk_bf16_f32 v16, v16, v16
    v_cvt_pk_bf16_f32 v17, v17, v17
    v_cvt_pk_bf16_f32 v18, v18, v18
    v_cvt_pk_bf16_f32 v19, v19, v19
    v_lshlrev_b32 v16, 16, v16
    v_lshlrev_b32 v17, 16, v17
    v_lshlrev_b32 v18, 16, v18
    v_lshlrev_b32 v19, 16, v19
    v_cvt_pk_bf16_f32 v24, v208, v208
    v_cvt_pk_bf16_f32 v25, v209, v209
    v_cvt_pk_bf16_f32 v26, v210, v210
    v_cvt_pk_bf16_f32 v27, v211, v211
    v_lshlrev_b32 v24, 16, v24
    v_lshlrev_b32 v25, 16, v25
    v_lshlrev_b32 v26, 16, v26
    v_lshlrev_b32 v27, 16, v27
    v_mul_f32 v12, v16, v24
    v_mul_f32 v13, v17, v25
    v_mul_f32 v14, v18, v26
    v_mul_f32 v15, v19, v27
    v_cvt_pk_bf16_f32 v8, v12, v13
    v_cvt_pk_bf16_f32 v9, v14, v15
    ds_write_b64 v6, v[8:9] offset:49280
    v_cvt_pk_bf16_f32 v16, v144, v144
    v_cvt_pk_bf16_f32 v17, v145, v145
    v_cvt_pk_bf16_f32 v18, v146, v146
    v_cvt_pk_bf16_f32 v19, v147, v147
    v_lshlrev_b32 v16, 16, v16
    v_lshlrev_b32 v17, 16, v17
    v_lshlrev_b32 v18, 16, v18
    v_lshlrev_b32 v19, 16, v19
    v_mul_f32 v20, 0xbfb8aa3b, v16
    v_mul_f32 v21, 0xbfb8aa3b, v17
    v_mul_f32 v22, 0xbfb8aa3b, v18
    v_mul_f32 v23, 0xbfb8aa3b, v19
    v_exp_f32 v20, v20
    v_exp_f32 v21, v21
    v_exp_f32 v22, v22
    v_exp_f32 v23, v23
    v_add_f32 v20, 1.0, v20
    v_add_f32 v21, 1.0, v21
    v_add_f32 v22, 1.0, v22
    v_add_f32 v23, 1.0, v23
    v_rcp_f32 v20, v20
    v_rcp_f32 v21, v21
    v_rcp_f32 v22, v22
    v_rcp_f32 v23, v23
    v_mul_f32 v16, v16, v20
    v_mul_f32 v17, v17, v21
    v_mul_f32 v18, v18, v22
    v_mul_f32 v19, v19, v23
    v_cvt_pk_bf16_f32 v16, v16, v16
    v_cvt_pk_bf16_f32 v17, v17, v17
    v_cvt_pk_bf16_f32 v18, v18, v18
    v_cvt_pk_bf16_f32 v19, v19, v19
    v_lshlrev_b32 v16, 16, v16
    v_lshlrev_b32 v17, 16, v17
    v_lshlrev_b32 v18, 16, v18
    v_lshlrev_b32 v19, 16, v19
    v_cvt_pk_bf16_f32 v24, v224, v224
    v_cvt_pk_bf16_f32 v25, v225, v225
    v_cvt_pk_bf16_f32 v26, v226, v226
    v_cvt_pk_bf16_f32 v27, v227, v227
    v_lshlrev_b32 v24, 16, v24
    v_lshlrev_b32 v25, 16, v25
    v_lshlrev_b32 v26, 16, v26
    v_lshlrev_b32 v27, 16, v27
    v_mul_f32 v12, v16, v24
    v_mul_f32 v13, v17, v25
    v_mul_f32 v14, v18, v26
    v_mul_f32 v15, v19, v27
    v_cvt_pk_bf16_f32 v8, v12, v13
    v_cvt_pk_bf16_f32 v9, v14, v15
    ds_write_b64 v6, v[8:9] offset:49312
    v_cvt_pk_bf16_f32 v16, v160, v160
    v_cvt_pk_bf16_f32 v17, v161, v161
    v_cvt_pk_bf16_f32 v18, v162, v162
    v_cvt_pk_bf16_f32 v19, v163, v163
    v_lshlrev_b32 v16, 16, v16
    v_lshlrev_b32 v17, 16, v17
    v_lshlrev_b32 v18, 16, v18
    v_lshlrev_b32 v19, 16, v19
    v_mul_f32 v20, 0xbfb8aa3b, v16
    v_mul_f32 v21, 0xbfb8aa3b, v17
    v_mul_f32 v22, 0xbfb8aa3b, v18
    v_mul_f32 v23, 0xbfb8aa3b, v19
    v_exp_f32 v20, v20
    v_exp_f32 v21, v21
    v_exp_f32 v22, v22
    v_exp_f32 v23, v23
    v_add_f32 v20, 1.0, v20
    v_add_f32 v21, 1.0, v21
    v_add_f32 v22, 1.0, v22
    v_add_f32 v23, 1.0, v23
    v_rcp_f32 v20, v20
    v_rcp_f32 v21, v21
    v_rcp_f32 v22, v22
    v_rcp_f32 v23, v23
    v_mul_f32 v16, v16, v20
    v_mul_f32 v17, v17, v21
    v_mul_f32 v18, v18, v22
    v_mul_f32 v19, v19, v23
    v_cvt_pk_bf16_f32 v16, v16, v16
    v_cvt_pk_bf16_f32 v17, v17, v17
    v_cvt_pk_bf16_f32 v18, v18, v18
    v_cvt_pk_bf16_f32 v19, v19, v19
    v_lshlrev_b32 v16, 16, v16
    v_lshlrev_b32 v17, 16, v17
    v_lshlrev_b32 v18, 16, v18
    v_lshlrev_b32 v19, 16, v19
    v_cvt_pk_bf16_f32 v24, v240, v240
    v_cvt_pk_bf16_f32 v25, v241, v241
    v_cvt_pk_bf16_f32 v26, v242, v242
    v_cvt_pk_bf16_f32 v27, v243, v243
    v_lshlrev_b32 v24, 16, v24
    v_lshlrev_b32 v25, 16, v25
    v_lshlrev_b32 v26, 16, v26
    v_lshlrev_b32 v27, 16, v27
    v_mul_f32 v12, v16, v24
    v_mul_f32 v13, v17, v25
    v_mul_f32 v14, v18, v26
    v_mul_f32 v15, v19, v27
    v_cvt_pk_bf16_f32 v8, v12, v13
    v_cvt_pk_bf16_f32 v9, v14, v15
    ds_write_b64 v6, v[8:9] offset:49344
    v_cvt_pk_bf16_f32 v16, v100, v100
    v_cvt_pk_bf16_f32 v17, v101, v101
    v_cvt_pk_bf16_f32 v18, v102, v102
    v_cvt_pk_bf16_f32 v19, v103, v103
    v_lshlrev_b32 v16, 16, v16
    v_lshlrev_b32 v17, 16, v17
    v_lshlrev_b32 v18, 16, v18
    v_lshlrev_b32 v19, 16, v19
    v_mul_f32 v20, 0xbfb8aa3b, v16
    v_mul_f32 v21, 0xbfb8aa3b, v17
    v_mul_f32 v22, 0xbfb8aa3b, v18
    v_mul_f32 v23, 0xbfb8aa3b, v19
    v_exp_f32 v20, v20
    v_exp_f32 v21, v21
    v_exp_f32 v22, v22
    v_exp_f32 v23, v23
    v_add_f32 v20, 1.0, v20
    v_add_f32 v21, 1.0, v21
    v_add_f32 v22, 1.0, v22
    v_add_f32 v23, 1.0, v23
    v_rcp_f32 v20, v20
    v_rcp_f32 v21, v21
    v_rcp_f32 v22, v22
    v_rcp_f32 v23, v23
    v_mul_f32 v16, v16, v20
    v_mul_f32 v17, v17, v21
    v_mul_f32 v18, v18, v22
    v_mul_f32 v19, v19, v23
    v_cvt_pk_bf16_f32 v16, v16, v16
    v_cvt_pk_bf16_f32 v17, v17, v17
    v_cvt_pk_bf16_f32 v18, v18, v18
    v_cvt_pk_bf16_f32 v19, v19, v19
    v_lshlrev_b32 v16, 16, v16
    v_lshlrev_b32 v17, 16, v17
    v_lshlrev_b32 v18, 16, v18
    v_lshlrev_b32 v19, 16, v19
    v_cvt_pk_bf16_f32 v24, v180, v180
    v_cvt_pk_bf16_f32 v25, v181, v181
    v_cvt_pk_bf16_f32 v26, v182, v182
    v_cvt_pk_bf16_f32 v27, v183, v183
    v_lshlrev_b32 v24, 16, v24
    v_lshlrev_b32 v25, 16, v25
    v_lshlrev_b32 v26, 16, v26
    v_lshlrev_b32 v27, 16, v27
    v_mul_f32 v12, v16, v24
    v_mul_f32 v13, v17, v25
    v_mul_f32 v14, v18, v26
    v_mul_f32 v15, v19, v27
    v_cvt_pk_bf16_f32 v8, v12, v13
    v_cvt_pk_bf16_f32 v9, v14, v15
    ds_write_b64 v6, v[8:9] offset:52800
    v_cvt_pk_bf16_f32 v16, v116, v116
    v_cvt_pk_bf16_f32 v17, v117, v117
    v_cvt_pk_bf16_f32 v18, v118, v118
    v_cvt_pk_bf16_f32 v19, v119, v119
    v_lshlrev_b32 v16, 16, v16
    v_lshlrev_b32 v17, 16, v17
    v_lshlrev_b32 v18, 16, v18
    v_lshlrev_b32 v19, 16, v19
    v_mul_f32 v20, 0xbfb8aa3b, v16
    v_mul_f32 v21, 0xbfb8aa3b, v17
    v_mul_f32 v22, 0xbfb8aa3b, v18
    v_mul_f32 v23, 0xbfb8aa3b, v19
    v_exp_f32 v20, v20
    v_exp_f32 v21, v21
    v_exp_f32 v22, v22
    v_exp_f32 v23, v23
    v_add_f32 v20, 1.0, v20
    v_add_f32 v21, 1.0, v21
    v_add_f32 v22, 1.0, v22
    v_add_f32 v23, 1.0, v23
    v_rcp_f32 v20, v20
    v_rcp_f32 v21, v21
    v_rcp_f32 v22, v22
    v_rcp_f32 v23, v23
    v_mul_f32 v16, v16, v20
    v_mul_f32 v17, v17, v21
    v_mul_f32 v18, v18, v22
    v_mul_f32 v19, v19, v23
    v_cvt_pk_bf16_f32 v16, v16, v16
    v_cvt_pk_bf16_f32 v17, v17, v17
    v_cvt_pk_bf16_f32 v18, v18, v18
    v_cvt_pk_bf16_f32 v19, v19, v19
    v_lshlrev_b32 v16, 16, v16
    v_lshlrev_b32 v17, 16, v17
    v_lshlrev_b32 v18, 16, v18
    v_lshlrev_b32 v19, 16, v19
    v_cvt_pk_bf16_f32 v24, v196, v196
    v_cvt_pk_bf16_f32 v25, v197, v197
    v_cvt_pk_bf16_f32 v26, v198, v198
    v_cvt_pk_bf16_f32 v27, v199, v199
    v_lshlrev_b32 v24, 16, v24
    v_lshlrev_b32 v25, 16, v25
    v_lshlrev_b32 v26, 16, v26
    v_lshlrev_b32 v27, 16, v27
    v_mul_f32 v12, v16, v24
    v_mul_f32 v13, v17, v25
    v_mul_f32 v14, v18, v26
    v_mul_f32 v15, v19, v27
    v_cvt_pk_bf16_f32 v8, v12, v13
    v_cvt_pk_bf16_f32 v9, v14, v15
    ds_write_b64 v6, v[8:9] offset:52832
    v_cvt_pk_bf16_f32 v16, v132, v132
    v_cvt_pk_bf16_f32 v17, v133, v133
    v_cvt_pk_bf16_f32 v18, v134, v134
    v_cvt_pk_bf16_f32 v19, v135, v135
    v_lshlrev_b32 v16, 16, v16
    v_lshlrev_b32 v17, 16, v17
    v_lshlrev_b32 v18, 16, v18
    v_lshlrev_b32 v19, 16, v19
    v_mul_f32 v20, 0xbfb8aa3b, v16
    v_mul_f32 v21, 0xbfb8aa3b, v17
    v_mul_f32 v22, 0xbfb8aa3b, v18
    v_mul_f32 v23, 0xbfb8aa3b, v19
    v_exp_f32 v20, v20
    v_exp_f32 v21, v21
    v_exp_f32 v22, v22
    v_exp_f32 v23, v23
    v_add_f32 v20, 1.0, v20
    v_add_f32 v21, 1.0, v21
    v_add_f32 v22, 1.0, v22
    v_add_f32 v23, 1.0, v23
    v_rcp_f32 v20, v20
    v_rcp_f32 v21, v21
    v_rcp_f32 v22, v22
    v_rcp_f32 v23, v23
    v_mul_f32 v16, v16, v20
    v_mul_f32 v17, v17, v21
    v_mul_f32 v18, v18, v22
    v_mul_f32 v19, v19, v23
    v_cvt_pk_bf16_f32 v16, v16, v16
    v_cvt_pk_bf16_f32 v17, v17, v17
    v_cvt_pk_bf16_f32 v18, v18, v18
    v_cvt_pk_bf16_f32 v19, v19, v19
    v_lshlrev_b32 v16, 16, v16
    v_lshlrev_b32 v17, 16, v17
    v_lshlrev_b32 v18, 16, v18
    v_lshlrev_b32 v19, 16, v19
    v_cvt_pk_bf16_f32 v24, v212, v212
    v_cvt_pk_bf16_f32 v25, v213, v213
    v_cvt_pk_bf16_f32 v26, v214, v214
    v_cvt_pk_bf16_f32 v27, v215, v215
    v_lshlrev_b32 v24, 16, v24
    v_lshlrev_b32 v25, 16, v25
    v_lshlrev_b32 v26, 16, v26
    v_lshlrev_b32 v27, 16, v27
    v_mul_f32 v12, v16, v24
    v_mul_f32 v13, v17, v25
    v_mul_f32 v14, v18, v26
    v_mul_f32 v15, v19, v27
    v_cvt_pk_bf16_f32 v8, v12, v13
    v_cvt_pk_bf16_f32 v9, v14, v15
    ds_write_b64 v6, v[8:9] offset:52864
    v_cvt_pk_bf16_f32 v16, v148, v148
    v_cvt_pk_bf16_f32 v17, v149, v149
    v_cvt_pk_bf16_f32 v18, v150, v150
    v_cvt_pk_bf16_f32 v19, v151, v151
    v_lshlrev_b32 v16, 16, v16
    v_lshlrev_b32 v17, 16, v17
    v_lshlrev_b32 v18, 16, v18
    v_lshlrev_b32 v19, 16, v19
    v_mul_f32 v20, 0xbfb8aa3b, v16
    v_mul_f32 v21, 0xbfb8aa3b, v17
    v_mul_f32 v22, 0xbfb8aa3b, v18
    v_mul_f32 v23, 0xbfb8aa3b, v19
    v_exp_f32 v20, v20
    v_exp_f32 v21, v21
    v_exp_f32 v22, v22
    v_exp_f32 v23, v23
    v_add_f32 v20, 1.0, v20
    v_add_f32 v21, 1.0, v21
    v_add_f32 v22, 1.0, v22
    v_add_f32 v23, 1.0, v23
    v_rcp_f32 v20, v20
    v_rcp_f32 v21, v21
    v_rcp_f32 v22, v22
    v_rcp_f32 v23, v23
    v_mul_f32 v16, v16, v20
    v_mul_f32 v17, v17, v21
    v_mul_f32 v18, v18, v22
    v_mul_f32 v19, v19, v23
    v_cvt_pk_bf16_f32 v16, v16, v16
    v_cvt_pk_bf16_f32 v17, v17, v17
    v_cvt_pk_bf16_f32 v18, v18, v18
    v_cvt_pk_bf16_f32 v19, v19, v19
    v_lshlrev_b32 v16, 16, v16
    v_lshlrev_b32 v17, 16, v17
    v_lshlrev_b32 v18, 16, v18
    v_lshlrev_b32 v19, 16, v19
    v_cvt_pk_bf16_f32 v24, v228, v228
    v_cvt_pk_bf16_f32 v25, v229, v229
    v_cvt_pk_bf16_f32 v26, v230, v230
    v_cvt_pk_bf16_f32 v27, v231, v231
    v_lshlrev_b32 v24, 16, v24
    v_lshlrev_b32 v25, 16, v25
    v_lshlrev_b32 v26, 16, v26
    v_lshlrev_b32 v27, 16, v27
    v_mul_f32 v12, v16, v24
    v_mul_f32 v13, v17, v25
    v_mul_f32 v14, v18, v26
    v_mul_f32 v15, v19, v27
    v_cvt_pk_bf16_f32 v8, v12, v13
    v_cvt_pk_bf16_f32 v9, v14, v15
    ds_write_b64 v6, v[8:9] offset:52896
    v_cvt_pk_bf16_f32 v16, v164, v164
    v_cvt_pk_bf16_f32 v17, v165, v165
    v_cvt_pk_bf16_f32 v18, v166, v166
    v_cvt_pk_bf16_f32 v19, v167, v167
    v_lshlrev_b32 v16, 16, v16
    v_lshlrev_b32 v17, 16, v17
    v_lshlrev_b32 v18, 16, v18
    v_lshlrev_b32 v19, 16, v19
    v_mul_f32 v20, 0xbfb8aa3b, v16
    v_mul_f32 v21, 0xbfb8aa3b, v17
    v_mul_f32 v22, 0xbfb8aa3b, v18
    v_mul_f32 v23, 0xbfb8aa3b, v19
    v_exp_f32 v20, v20
    v_exp_f32 v21, v21
    v_exp_f32 v22, v22
    v_exp_f32 v23, v23
    v_add_f32 v20, 1.0, v20
    v_add_f32 v21, 1.0, v21
    v_add_f32 v22, 1.0, v22
    v_add_f32 v23, 1.0, v23
    v_rcp_f32 v20, v20
    v_rcp_f32 v21, v21
    v_rcp_f32 v22, v22
    v_rcp_f32 v23, v23
    v_mul_f32 v16, v16, v20
    v_mul_f32 v17, v17, v21
    v_mul_f32 v18, v18, v22
    v_mul_f32 v19, v19, v23
    v_cvt_pk_bf16_f32 v16, v16, v16
    v_cvt_pk_bf16_f32 v17, v17, v17
    v_cvt_pk_bf16_f32 v18, v18, v18
    v_cvt_pk_bf16_f32 v19, v19, v19
    v_lshlrev_b32 v16, 16, v16
    v_lshlrev_b32 v17, 16, v17
    v_lshlrev_b32 v18, 16, v18
    v_lshlrev_b32 v19, 16, v19
    v_cvt_pk_bf16_f32 v24, v244, v244
    v_cvt_pk_bf16_f32 v25, v245, v245
    v_cvt_pk_bf16_f32 v26, v246, v246
    v_cvt_pk_bf16_f32 v27, v247, v247
    v_lshlrev_b32 v24, 16, v24
    v_lshlrev_b32 v25, 16, v25
    v_lshlrev_b32 v26, 16, v26
    v_lshlrev_b32 v27, 16, v27
    v_mul_f32 v12, v16, v24
    v_mul_f32 v13, v17, v25
    v_mul_f32 v14, v18, v26
    v_mul_f32 v15, v19, v27
    v_cvt_pk_bf16_f32 v8, v12, v13
    v_cvt_pk_bf16_f32 v9, v14, v15
    ds_write_b64 v6, v[8:9] offset:52928
    v_cvt_pk_bf16_f32 v16, v104, v104
    v_cvt_pk_bf16_f32 v17, v105, v105
    v_cvt_pk_bf16_f32 v18, v106, v106
    v_cvt_pk_bf16_f32 v19, v107, v107
    v_lshlrev_b32 v16, 16, v16
    v_lshlrev_b32 v17, 16, v17
    v_lshlrev_b32 v18, 16, v18
    v_lshlrev_b32 v19, 16, v19
    v_mul_f32 v20, 0xbfb8aa3b, v16
    v_mul_f32 v21, 0xbfb8aa3b, v17
    v_mul_f32 v22, 0xbfb8aa3b, v18
    v_mul_f32 v23, 0xbfb8aa3b, v19
    v_exp_f32 v20, v20
    v_exp_f32 v21, v21
    v_exp_f32 v22, v22
    v_exp_f32 v23, v23
    v_add_f32 v20, 1.0, v20
    v_add_f32 v21, 1.0, v21
    v_add_f32 v22, 1.0, v22
    v_add_f32 v23, 1.0, v23
    v_rcp_f32 v20, v20
    v_rcp_f32 v21, v21
    v_rcp_f32 v22, v22
    v_rcp_f32 v23, v23
    v_mul_f32 v16, v16, v20
    v_mul_f32 v17, v17, v21
    v_mul_f32 v18, v18, v22
    v_mul_f32 v19, v19, v23
    v_cvt_pk_bf16_f32 v16, v16, v16
    v_cvt_pk_bf16_f32 v17, v17, v17
    v_cvt_pk_bf16_f32 v18, v18, v18
    v_cvt_pk_bf16_f32 v19, v19, v19
    v_lshlrev_b32 v16, 16, v16
    v_lshlrev_b32 v17, 16, v17
    v_lshlrev_b32 v18, 16, v18
    v_lshlrev_b32 v19, 16, v19
    v_cvt_pk_bf16_f32 v24, v184, v184
    v_cvt_pk_bf16_f32 v25, v185, v185
    v_cvt_pk_bf16_f32 v26, v186, v186
    v_cvt_pk_bf16_f32 v27, v187, v187
    v_lshlrev_b32 v24, 16, v24
    v_lshlrev_b32 v25, 16, v25
    v_lshlrev_b32 v26, 16, v26
    v_lshlrev_b32 v27, 16, v27
    v_mul_f32 v12, v16, v24
    v_mul_f32 v13, v17, v25
    v_mul_f32 v14, v18, v26
    v_mul_f32 v15, v19, v27
    v_cvt_pk_bf16_f32 v8, v12, v13
    v_cvt_pk_bf16_f32 v9, v14, v15
    ds_write_b64 v6, v[8:9] offset:56384
    v_cvt_pk_bf16_f32 v16, v120, v120
    v_cvt_pk_bf16_f32 v17, v121, v121
    v_cvt_pk_bf16_f32 v18, v122, v122
    v_cvt_pk_bf16_f32 v19, v123, v123
    v_lshlrev_b32 v16, 16, v16
    v_lshlrev_b32 v17, 16, v17
    v_lshlrev_b32 v18, 16, v18
    v_lshlrev_b32 v19, 16, v19
    v_mul_f32 v20, 0xbfb8aa3b, v16
    v_mul_f32 v21, 0xbfb8aa3b, v17
    v_mul_f32 v22, 0xbfb8aa3b, v18
    v_mul_f32 v23, 0xbfb8aa3b, v19
    v_exp_f32 v20, v20
    v_exp_f32 v21, v21
    v_exp_f32 v22, v22
    v_exp_f32 v23, v23
    v_add_f32 v20, 1.0, v20
    v_add_f32 v21, 1.0, v21
    v_add_f32 v22, 1.0, v22
    v_add_f32 v23, 1.0, v23
    v_rcp_f32 v20, v20
    v_rcp_f32 v21, v21
    v_rcp_f32 v22, v22
    v_rcp_f32 v23, v23
    v_mul_f32 v16, v16, v20
    v_mul_f32 v17, v17, v21
    v_mul_f32 v18, v18, v22
    v_mul_f32 v19, v19, v23
    v_cvt_pk_bf16_f32 v16, v16, v16
    v_cvt_pk_bf16_f32 v17, v17, v17
    v_cvt_pk_bf16_f32 v18, v18, v18
    v_cvt_pk_bf16_f32 v19, v19, v19
    v_lshlrev_b32 v16, 16, v16
    v_lshlrev_b32 v17, 16, v17
    v_lshlrev_b32 v18, 16, v18
    v_lshlrev_b32 v19, 16, v19
    v_cvt_pk_bf16_f32 v24, v200, v200
    v_cvt_pk_bf16_f32 v25, v201, v201
    v_cvt_pk_bf16_f32 v26, v202, v202
    v_cvt_pk_bf16_f32 v27, v203, v203
    v_lshlrev_b32 v24, 16, v24
    v_lshlrev_b32 v25, 16, v25
    v_lshlrev_b32 v26, 16, v26
    v_lshlrev_b32 v27, 16, v27
    v_mul_f32 v12, v16, v24
    v_mul_f32 v13, v17, v25
    v_mul_f32 v14, v18, v26
    v_mul_f32 v15, v19, v27
    v_cvt_pk_bf16_f32 v8, v12, v13
    v_cvt_pk_bf16_f32 v9, v14, v15
    ds_write_b64 v6, v[8:9] offset:56416
    v_cvt_pk_bf16_f32 v16, v136, v136
    v_cvt_pk_bf16_f32 v17, v137, v137
    v_cvt_pk_bf16_f32 v18, v138, v138
    v_cvt_pk_bf16_f32 v19, v139, v139
    v_lshlrev_b32 v16, 16, v16
    v_lshlrev_b32 v17, 16, v17
    v_lshlrev_b32 v18, 16, v18
    v_lshlrev_b32 v19, 16, v19
    v_mul_f32 v20, 0xbfb8aa3b, v16
    v_mul_f32 v21, 0xbfb8aa3b, v17
    v_mul_f32 v22, 0xbfb8aa3b, v18
    v_mul_f32 v23, 0xbfb8aa3b, v19
    v_exp_f32 v20, v20
    v_exp_f32 v21, v21
    v_exp_f32 v22, v22
    v_exp_f32 v23, v23
    v_add_f32 v20, 1.0, v20
    v_add_f32 v21, 1.0, v21
    v_add_f32 v22, 1.0, v22
    v_add_f32 v23, 1.0, v23
    v_rcp_f32 v20, v20
    v_rcp_f32 v21, v21
    v_rcp_f32 v22, v22
    v_rcp_f32 v23, v23
    v_mul_f32 v16, v16, v20
    v_mul_f32 v17, v17, v21
    v_mul_f32 v18, v18, v22
    v_mul_f32 v19, v19, v23
    v_cvt_pk_bf16_f32 v16, v16, v16
    v_cvt_pk_bf16_f32 v17, v17, v17
    v_cvt_pk_bf16_f32 v18, v18, v18
    v_cvt_pk_bf16_f32 v19, v19, v19
    v_lshlrev_b32 v16, 16, v16
    v_lshlrev_b32 v17, 16, v17
    v_lshlrev_b32 v18, 16, v18
    v_lshlrev_b32 v19, 16, v19
    v_cvt_pk_bf16_f32 v24, v216, v216
    v_cvt_pk_bf16_f32 v25, v217, v217
    v_cvt_pk_bf16_f32 v26, v218, v218
    v_cvt_pk_bf16_f32 v27, v219, v219
    v_lshlrev_b32 v24, 16, v24
    v_lshlrev_b32 v25, 16, v25
    v_lshlrev_b32 v26, 16, v26
    v_lshlrev_b32 v27, 16, v27
    v_mul_f32 v12, v16, v24
    v_mul_f32 v13, v17, v25
    v_mul_f32 v14, v18, v26
    v_mul_f32 v15, v19, v27
    v_cvt_pk_bf16_f32 v8, v12, v13
    v_cvt_pk_bf16_f32 v9, v14, v15
    ds_write_b64 v6, v[8:9] offset:56448
    v_cvt_pk_bf16_f32 v16, v152, v152
    v_cvt_pk_bf16_f32 v17, v153, v153
    v_cvt_pk_bf16_f32 v18, v154, v154
    v_cvt_pk_bf16_f32 v19, v155, v155
    v_lshlrev_b32 v16, 16, v16
    v_lshlrev_b32 v17, 16, v17
    v_lshlrev_b32 v18, 16, v18
    v_lshlrev_b32 v19, 16, v19
    v_mul_f32 v20, 0xbfb8aa3b, v16
    v_mul_f32 v21, 0xbfb8aa3b, v17
    v_mul_f32 v22, 0xbfb8aa3b, v18
    v_mul_f32 v23, 0xbfb8aa3b, v19
    v_exp_f32 v20, v20
    v_exp_f32 v21, v21
    v_exp_f32 v22, v22
    v_exp_f32 v23, v23
    v_add_f32 v20, 1.0, v20
    v_add_f32 v21, 1.0, v21
    v_add_f32 v22, 1.0, v22
    v_add_f32 v23, 1.0, v23
    v_rcp_f32 v20, v20
    v_rcp_f32 v21, v21
    v_rcp_f32 v22, v22
    v_rcp_f32 v23, v23
    v_mul_f32 v16, v16, v20
    v_mul_f32 v17, v17, v21
    v_mul_f32 v18, v18, v22
    v_mul_f32 v19, v19, v23
    v_cvt_pk_bf16_f32 v16, v16, v16
    v_cvt_pk_bf16_f32 v17, v17, v17
    v_cvt_pk_bf16_f32 v18, v18, v18
    v_cvt_pk_bf16_f32 v19, v19, v19
    v_lshlrev_b32 v16, 16, v16
    v_lshlrev_b32 v17, 16, v17
    v_lshlrev_b32 v18, 16, v18
    v_lshlrev_b32 v19, 16, v19
    v_cvt_pk_bf16_f32 v24, v232, v232
    v_cvt_pk_bf16_f32 v25, v233, v233
    v_cvt_pk_bf16_f32 v26, v234, v234
    v_cvt_pk_bf16_f32 v27, v235, v235
    v_lshlrev_b32 v24, 16, v24
    v_lshlrev_b32 v25, 16, v25
    v_lshlrev_b32 v26, 16, v26
    v_lshlrev_b32 v27, 16, v27
    v_mul_f32 v12, v16, v24
    v_mul_f32 v13, v17, v25
    v_mul_f32 v14, v18, v26
    v_mul_f32 v15, v19, v27
    v_cvt_pk_bf16_f32 v8, v12, v13
    v_cvt_pk_bf16_f32 v9, v14, v15
    ds_write_b64 v6, v[8:9] offset:56480
    v_cvt_pk_bf16_f32 v16, v168, v168
    v_cvt_pk_bf16_f32 v17, v169, v169
    v_cvt_pk_bf16_f32 v18, v170, v170
    v_cvt_pk_bf16_f32 v19, v171, v171
    v_lshlrev_b32 v16, 16, v16
    v_lshlrev_b32 v17, 16, v17
    v_lshlrev_b32 v18, 16, v18
    v_lshlrev_b32 v19, 16, v19
    v_mul_f32 v20, 0xbfb8aa3b, v16
    v_mul_f32 v21, 0xbfb8aa3b, v17
    v_mul_f32 v22, 0xbfb8aa3b, v18
    v_mul_f32 v23, 0xbfb8aa3b, v19
    v_exp_f32 v20, v20
    v_exp_f32 v21, v21
    v_exp_f32 v22, v22
    v_exp_f32 v23, v23
    v_add_f32 v20, 1.0, v20
    v_add_f32 v21, 1.0, v21
    v_add_f32 v22, 1.0, v22
    v_add_f32 v23, 1.0, v23
    v_rcp_f32 v20, v20
    v_rcp_f32 v21, v21
    v_rcp_f32 v22, v22
    v_rcp_f32 v23, v23
    v_mul_f32 v16, v16, v20
    v_mul_f32 v17, v17, v21
    v_mul_f32 v18, v18, v22
    v_mul_f32 v19, v19, v23
    v_cvt_pk_bf16_f32 v16, v16, v16
    v_cvt_pk_bf16_f32 v17, v17, v17
    v_cvt_pk_bf16_f32 v18, v18, v18
    v_cvt_pk_bf16_f32 v19, v19, v19
    v_lshlrev_b32 v16, 16, v16
    v_lshlrev_b32 v17, 16, v17
    v_lshlrev_b32 v18, 16, v18
    v_lshlrev_b32 v19, 16, v19
    v_cvt_pk_bf16_f32 v24, v248, v248
    v_cvt_pk_bf16_f32 v25, v249, v249
    v_cvt_pk_bf16_f32 v26, v250, v250
    v_cvt_pk_bf16_f32 v27, v251, v251
    v_lshlrev_b32 v24, 16, v24
    v_lshlrev_b32 v25, 16, v25
    v_lshlrev_b32 v26, 16, v26
    v_lshlrev_b32 v27, 16, v27
    v_mul_f32 v12, v16, v24
    v_mul_f32 v13, v17, v25
    v_mul_f32 v14, v18, v26
    v_mul_f32 v15, v19, v27
    v_cvt_pk_bf16_f32 v8, v12, v13
    v_cvt_pk_bf16_f32 v9, v14, v15
    ds_write_b64 v6, v[8:9] offset:56512
    v_cvt_pk_bf16_f32 v16, v108, v108
    v_cvt_pk_bf16_f32 v17, v109, v109
    v_cvt_pk_bf16_f32 v18, v110, v110
    v_cvt_pk_bf16_f32 v19, v111, v111
    v_lshlrev_b32 v16, 16, v16
    v_lshlrev_b32 v17, 16, v17
    v_lshlrev_b32 v18, 16, v18
    v_lshlrev_b32 v19, 16, v19
    v_mul_f32 v20, 0xbfb8aa3b, v16
    v_mul_f32 v21, 0xbfb8aa3b, v17
    v_mul_f32 v22, 0xbfb8aa3b, v18
    v_mul_f32 v23, 0xbfb8aa3b, v19
    v_exp_f32 v20, v20
    v_exp_f32 v21, v21
    v_exp_f32 v22, v22
    v_exp_f32 v23, v23
    v_add_f32 v20, 1.0, v20
    v_add_f32 v21, 1.0, v21
    v_add_f32 v22, 1.0, v22
    v_add_f32 v23, 1.0, v23
    v_rcp_f32 v20, v20
    v_rcp_f32 v21, v21
    v_rcp_f32 v22, v22
    v_rcp_f32 v23, v23
    v_mul_f32 v16, v16, v20
    v_mul_f32 v17, v17, v21
    v_mul_f32 v18, v18, v22
    v_mul_f32 v19, v19, v23
    v_cvt_pk_bf16_f32 v16, v16, v16
    v_cvt_pk_bf16_f32 v17, v17, v17
    v_cvt_pk_bf16_f32 v18, v18, v18
    v_cvt_pk_bf16_f32 v19, v19, v19
    v_lshlrev_b32 v16, 16, v16
    v_lshlrev_b32 v17, 16, v17
    v_lshlrev_b32 v18, 16, v18
    v_lshlrev_b32 v19, 16, v19
    v_cvt_pk_bf16_f32 v24, v188, v188
    v_cvt_pk_bf16_f32 v25, v189, v189
    v_cvt_pk_bf16_f32 v26, v190, v190
    v_cvt_pk_bf16_f32 v27, v191, v191
    v_lshlrev_b32 v24, 16, v24
    v_lshlrev_b32 v25, 16, v25
    v_lshlrev_b32 v26, 16, v26
    v_lshlrev_b32 v27, 16, v27
    v_mul_f32 v12, v16, v24
    v_mul_f32 v13, v17, v25
    v_mul_f32 v14, v18, v26
    v_mul_f32 v15, v19, v27
    v_cvt_pk_bf16_f32 v8, v12, v13
    v_cvt_pk_bf16_f32 v9, v14, v15
    ds_write_b64 v6, v[8:9] offset:59968
    v_cvt_pk_bf16_f32 v16, v124, v124
    v_cvt_pk_bf16_f32 v17, v125, v125
    v_cvt_pk_bf16_f32 v18, v126, v126
    v_cvt_pk_bf16_f32 v19, v127, v127
    v_lshlrev_b32 v16, 16, v16
    v_lshlrev_b32 v17, 16, v17
    v_lshlrev_b32 v18, 16, v18
    v_lshlrev_b32 v19, 16, v19
    v_mul_f32 v20, 0xbfb8aa3b, v16
    v_mul_f32 v21, 0xbfb8aa3b, v17
    v_mul_f32 v22, 0xbfb8aa3b, v18
    v_mul_f32 v23, 0xbfb8aa3b, v19
    v_exp_f32 v20, v20
    v_exp_f32 v21, v21
    v_exp_f32 v22, v22
    v_exp_f32 v23, v23
    v_add_f32 v20, 1.0, v20
    v_add_f32 v21, 1.0, v21
    v_add_f32 v22, 1.0, v22
    v_add_f32 v23, 1.0, v23
    v_rcp_f32 v20, v20
    v_rcp_f32 v21, v21
    v_rcp_f32 v22, v22
    v_rcp_f32 v23, v23
    v_mul_f32 v16, v16, v20
    v_mul_f32 v17, v17, v21
    v_mul_f32 v18, v18, v22
    v_mul_f32 v19, v19, v23
    v_cvt_pk_bf16_f32 v16, v16, v16
    v_cvt_pk_bf16_f32 v17, v17, v17
    v_cvt_pk_bf16_f32 v18, v18, v18
    v_cvt_pk_bf16_f32 v19, v19, v19
    v_lshlrev_b32 v16, 16, v16
    v_lshlrev_b32 v17, 16, v17
    v_lshlrev_b32 v18, 16, v18
    v_lshlrev_b32 v19, 16, v19
    v_cvt_pk_bf16_f32 v24, v204, v204
    v_cvt_pk_bf16_f32 v25, v205, v205
    v_cvt_pk_bf16_f32 v26, v206, v206
    v_cvt_pk_bf16_f32 v27, v207, v207
    v_lshlrev_b32 v24, 16, v24
    v_lshlrev_b32 v25, 16, v25
    v_lshlrev_b32 v26, 16, v26
    v_lshlrev_b32 v27, 16, v27
    v_mul_f32 v12, v16, v24
    v_mul_f32 v13, v17, v25
    v_mul_f32 v14, v18, v26
    v_mul_f32 v15, v19, v27
    v_cvt_pk_bf16_f32 v8, v12, v13
    v_cvt_pk_bf16_f32 v9, v14, v15
    ds_write_b64 v6, v[8:9] offset:60000
    v_cvt_pk_bf16_f32 v16, v140, v140
    v_cvt_pk_bf16_f32 v17, v141, v141
    v_cvt_pk_bf16_f32 v18, v142, v142
    v_cvt_pk_bf16_f32 v19, v143, v143
    v_lshlrev_b32 v16, 16, v16
    v_lshlrev_b32 v17, 16, v17
    v_lshlrev_b32 v18, 16, v18
    v_lshlrev_b32 v19, 16, v19
    v_mul_f32 v20, 0xbfb8aa3b, v16
    v_mul_f32 v21, 0xbfb8aa3b, v17
    v_mul_f32 v22, 0xbfb8aa3b, v18
    v_mul_f32 v23, 0xbfb8aa3b, v19
    v_exp_f32 v20, v20
    v_exp_f32 v21, v21
    v_exp_f32 v22, v22
    v_exp_f32 v23, v23
    v_add_f32 v20, 1.0, v20
    v_add_f32 v21, 1.0, v21
    v_add_f32 v22, 1.0, v22
    v_add_f32 v23, 1.0, v23
    v_rcp_f32 v20, v20
    v_rcp_f32 v21, v21
    v_rcp_f32 v22, v22
    v_rcp_f32 v23, v23
    v_mul_f32 v16, v16, v20
    v_mul_f32 v17, v17, v21
    v_mul_f32 v18, v18, v22
    v_mul_f32 v19, v19, v23
    v_cvt_pk_bf16_f32 v16, v16, v16
    v_cvt_pk_bf16_f32 v17, v17, v17
    v_cvt_pk_bf16_f32 v18, v18, v18
    v_cvt_pk_bf16_f32 v19, v19, v19
    v_lshlrev_b32 v16, 16, v16
    v_lshlrev_b32 v17, 16, v17
    v_lshlrev_b32 v18, 16, v18
    v_lshlrev_b32 v19, 16, v19
    v_cvt_pk_bf16_f32 v24, v220, v220
    v_cvt_pk_bf16_f32 v25, v221, v221
    v_cvt_pk_bf16_f32 v26, v222, v222
    v_cvt_pk_bf16_f32 v27, v223, v223
    v_lshlrev_b32 v24, 16, v24
    v_lshlrev_b32 v25, 16, v25
    v_lshlrev_b32 v26, 16, v26
    v_lshlrev_b32 v27, 16, v27
    v_mul_f32 v12, v16, v24
    v_mul_f32 v13, v17, v25
    v_mul_f32 v14, v18, v26
    v_mul_f32 v15, v19, v27
    v_cvt_pk_bf16_f32 v8, v12, v13
    v_cvt_pk_bf16_f32 v9, v14, v15
    ds_write_b64 v6, v[8:9] offset:60032
    v_cvt_pk_bf16_f32 v16, v156, v156
    v_cvt_pk_bf16_f32 v17, v157, v157
    v_cvt_pk_bf16_f32 v18, v158, v158
    v_cvt_pk_bf16_f32 v19, v159, v159
    v_lshlrev_b32 v16, 16, v16
    v_lshlrev_b32 v17, 16, v17
    v_lshlrev_b32 v18, 16, v18
    v_lshlrev_b32 v19, 16, v19
    v_mul_f32 v20, 0xbfb8aa3b, v16
    v_mul_f32 v21, 0xbfb8aa3b, v17
    v_mul_f32 v22, 0xbfb8aa3b, v18
    v_mul_f32 v23, 0xbfb8aa3b, v19
    v_exp_f32 v20, v20
    v_exp_f32 v21, v21
    v_exp_f32 v22, v22
    v_exp_f32 v23, v23
    v_add_f32 v20, 1.0, v20
    v_add_f32 v21, 1.0, v21
    v_add_f32 v22, 1.0, v22
    v_add_f32 v23, 1.0, v23
    v_rcp_f32 v20, v20
    v_rcp_f32 v21, v21
    v_rcp_f32 v22, v22
    v_rcp_f32 v23, v23
    v_mul_f32 v16, v16, v20
    v_mul_f32 v17, v17, v21
    v_mul_f32 v18, v18, v22
    v_mul_f32 v19, v19, v23
    v_cvt_pk_bf16_f32 v16, v16, v16
    v_cvt_pk_bf16_f32 v17, v17, v17
    v_cvt_pk_bf16_f32 v18, v18, v18
    v_cvt_pk_bf16_f32 v19, v19, v19
    v_lshlrev_b32 v16, 16, v16
    v_lshlrev_b32 v17, 16, v17
    v_lshlrev_b32 v18, 16, v18
    v_lshlrev_b32 v19, 16, v19
    v_cvt_pk_bf16_f32 v24, v236, v236
    v_cvt_pk_bf16_f32 v25, v237, v237
    v_cvt_pk_bf16_f32 v26, v238, v238
    v_cvt_pk_bf16_f32 v27, v239, v239
    v_lshlrev_b32 v24, 16, v24
    v_lshlrev_b32 v25, 16, v25
    v_lshlrev_b32 v26, 16, v26
    v_lshlrev_b32 v27, 16, v27
    v_mul_f32 v12, v16, v24
    v_mul_f32 v13, v17, v25
    v_mul_f32 v14, v18, v26
    v_mul_f32 v15, v19, v27
    v_cvt_pk_bf16_f32 v8, v12, v13
    v_cvt_pk_bf16_f32 v9, v14, v15
    ds_write_b64 v6, v[8:9] offset:60064
    v_cvt_pk_bf16_f32 v16, v172, v172
    v_cvt_pk_bf16_f32 v17, v173, v173
    v_cvt_pk_bf16_f32 v18, v174, v174
    v_cvt_pk_bf16_f32 v19, v175, v175
    v_lshlrev_b32 v16, 16, v16
    v_lshlrev_b32 v17, 16, v17
    v_lshlrev_b32 v18, 16, v18
    v_lshlrev_b32 v19, 16, v19
    v_mul_f32 v20, 0xbfb8aa3b, v16
    v_mul_f32 v21, 0xbfb8aa3b, v17
    v_mul_f32 v22, 0xbfb8aa3b, v18
    v_mul_f32 v23, 0xbfb8aa3b, v19
    v_exp_f32 v20, v20
    v_exp_f32 v21, v21
    v_exp_f32 v22, v22
    v_exp_f32 v23, v23
    v_add_f32 v20, 1.0, v20
    v_add_f32 v21, 1.0, v21
    v_add_f32 v22, 1.0, v22
    v_add_f32 v23, 1.0, v23
    v_rcp_f32 v20, v20
    v_rcp_f32 v21, v21
    v_rcp_f32 v22, v22
    v_rcp_f32 v23, v23
    v_mul_f32 v16, v16, v20
    v_mul_f32 v17, v17, v21
    v_mul_f32 v18, v18, v22
    v_mul_f32 v19, v19, v23
    v_cvt_pk_bf16_f32 v16, v16, v16
    v_cvt_pk_bf16_f32 v17, v17, v17
    v_cvt_pk_bf16_f32 v18, v18, v18
    v_cvt_pk_bf16_f32 v19, v19, v19
    v_lshlrev_b32 v16, 16, v16
    v_lshlrev_b32 v17, 16, v17
    v_lshlrev_b32 v18, 16, v18
    v_lshlrev_b32 v19, 16, v19
    v_cvt_pk_bf16_f32 v24, v252, v252
    v_cvt_pk_bf16_f32 v25, v253, v253
    v_cvt_pk_bf16_f32 v26, v254, v254
    v_cvt_pk_bf16_f32 v27, v255, v255
    v_lshlrev_b32 v24, 16, v24
    v_lshlrev_b32 v25, 16, v25
    v_lshlrev_b32 v26, 16, v26
    v_lshlrev_b32 v27, 16, v27
    v_mul_f32 v12, v16, v24
    v_mul_f32 v13, v17, v25
    v_mul_f32 v14, v18, v26
    v_mul_f32 v15, v19, v27
    v_cvt_pk_bf16_f32 v8, v12, v13
    v_cvt_pk_bf16_f32 v9, v14, v15
    ds_write_b64 v6, v[8:9] offset:60096
L_g1_ep_st_6:
    s_waitcnt lgkmcnt(0)
    s_barrier
    s_lshl_b32 s44, s38, 8
    s_lshl_b32 s45, s35, 5
    s_add_u32 s46, s44, s45
    s_mul_i32 s47, s39, 192
    s_add_u32 s47, s47, 4194304
    s_mul_i32 s48, s39, 224
    s_add_u32 s48, s48, 16777216
    v_add_u32 v10, 0, v2
    v_mul_u32_u24 v11, 5462, v10
    v_lshrrev_b32 v11, 16, v11
    v_mul_u32_u24 v12, 12, v11
    v_sub_u32 v12, v10, v12
    v_add_u32 v13, s45, v11
    v_mul_u32_u24 v14, 192, v13
    v_lshl_add_u32 v14, v12, 4, v14
    ds_read_b128 v[32:35], v14 offset:0
    v_add_u32 v13, s46, v11
    v_mul_u32_u24 v13, 6144, v13
    v_lshl_add_u32 v13, v12, 4, v13
    v_add_u32 v88, s47, v13
    v_add_u32 v10, 64, v2
    v_mul_u32_u24 v11, 5462, v10
    v_lshrrev_b32 v11, 16, v11
    v_mul_u32_u24 v12, 12, v11
    v_sub_u32 v12, v10, v12
    v_add_u32 v13, s45, v11
    v_mul_u32_u24 v14, 192, v13
    v_lshl_add_u32 v14, v12, 4, v14
    ds_read_b128 v[36:39], v14 offset:0
    v_add_u32 v13, s46, v11
    v_mul_u32_u24 v13, 6144, v13
    v_lshl_add_u32 v13, v12, 4, v13
    v_add_u32 v89, s47, v13
    v_add_u32 v10, 128, v2
    v_mul_u32_u24 v11, 5462, v10
    v_lshrrev_b32 v11, 16, v11
    v_mul_u32_u24 v12, 12, v11
    v_sub_u32 v12, v10, v12
    v_add_u32 v13, s45, v11
    v_mul_u32_u24 v14, 192, v13
    v_lshl_add_u32 v14, v12, 4, v14
    ds_read_b128 v[40:43], v14 offset:0
    v_add_u32 v13, s46, v11
    v_mul_u32_u24 v13, 6144, v13
    v_lshl_add_u32 v13, v12, 4, v13
    v_add_u32 v90, s47, v13
    v_add_u32 v10, 192, v2
    v_mul_u32_u24 v11, 5462, v10
    v_lshrrev_b32 v11, 16, v11
    v_mul_u32_u24 v12, 12, v11
    v_sub_u32 v12, v10, v12
    v_add_u32 v13, s45, v11
    v_mul_u32_u24 v14, 192, v13
    v_lshl_add_u32 v14, v12, 4, v14
    ds_read_b128 v[44:47], v14 offset:0
    v_add_u32 v13, s46, v11
    v_mul_u32_u24 v13, 6144, v13
    v_lshl_add_u32 v13, v12, 4, v13
    v_add_u32 v91, s47, v13
    v_add_u32 v10, 256, v2
    v_mul_u32_u24 v11, 5462, v10
    v_lshrrev_b32 v11, 16, v11
    v_mul_u32_u24 v12, 12, v11
    v_sub_u32 v12, v10, v12
    v_add_u32 v13, s45, v11
    v_mul_u32_u24 v14, 192, v13
    v_lshl_add_u32 v14, v12, 4, v14
    ds_read_b128 v[48:51], v14 offset:0
    v_add_u32 v13, s46, v11
    v_mul_u32_u24 v13, 6144, v13
    v_lshl_add_u32 v13, v12, 4, v13
    v_add_u32 v92, s47, v13
    v_add_u32 v10, 320, v2
    v_mul_u32_u24 v11, 5462, v10
    v_lshrrev_b32 v11, 16, v11
    v_mul_u32_u24 v12, 12, v11
    v_sub_u32 v12, v10, v12
    v_add_u32 v13, s45, v11
    v_mul_u32_u24 v14, 192, v13
    v_lshl_add_u32 v14, v12, 4, v14
    ds_read_b128 v[52:55], v14 offset:0
    v_add_u32 v13, s46, v11
    v_mul_u32_u24 v13, 6144, v13
    v_lshl_add_u32 v13, v12, 4, v13
    v_add_u32 v93, s47, v13
    v_add_u32 v10, 0, v2
    v_mul_u32_u24 v11, 4682, v10
    v_lshrrev_b32 v11, 16, v11
    v_mul_u32_u24 v12, 14, v11
    v_sub_u32 v12, v10, v12
    v_add_u32 v13, s45, v11
    v_mul_u32_u24 v14, 224, v13
    v_lshl_add_u32 v14, v12, 4, v14
    ds_read_b128 v[56:59], v14 offset:49152
    v_add_u32 v13, s46, v11
    v_mul_u32_u24 v13, 7168, v13
    v_lshl_add_u32 v13, v12, 4, v13
    v_add_u32 v94, s48, v13
    v_add_u32 v10, 64, v2
    v_mul_u32_u24 v11, 4682, v10
    v_lshrrev_b32 v11, 16, v11
    v_mul_u32_u24 v12, 14, v11
    v_sub_u32 v12, v10, v12
    v_add_u32 v13, s45, v11
    v_mul_u32_u24 v14, 224, v13
    v_lshl_add_u32 v14, v12, 4, v14
    ds_read_b128 v[60:63], v14 offset:49152
    v_add_u32 v13, s46, v11
    v_mul_u32_u24 v13, 7168, v13
    v_lshl_add_u32 v13, v12, 4, v13
    v_add_u32 v95, s48, v13
    v_add_u32 v10, 128, v2
    v_mul_u32_u24 v11, 4682, v10
    v_lshrrev_b32 v11, 16, v11
    v_mul_u32_u24 v12, 14, v11
    v_sub_u32 v12, v10, v12
    v_add_u32 v13, s45, v11
    v_mul_u32_u24 v14, 224, v13
    v_lshl_add_u32 v14, v12, 4, v14
    ds_read_b128 v[64:67], v14 offset:49152
    v_add_u32 v13, s46, v11
    v_mul_u32_u24 v13, 7168, v13
    v_lshl_add_u32 v13, v12, 4, v13
    v_add_u32 v96, s48, v13
    v_add_u32 v10, 192, v2
    v_mul_u32_u24 v11, 4682, v10
    v_lshrrev_b32 v11, 16, v11
    v_mul_u32_u24 v12, 14, v11
    v_sub_u32 v12, v10, v12
    v_add_u32 v13, s45, v11
    v_mul_u32_u24 v14, 224, v13
    v_lshl_add_u32 v14, v12, 4, v14
    ds_read_b128 v[68:71], v14 offset:49152
    v_add_u32 v13, s46, v11
    v_mul_u32_u24 v13, 7168, v13
    v_lshl_add_u32 v13, v12, 4, v13
    v_add_u32 v97, s48, v13
    v_add_u32 v10, 256, v2
    v_mul_u32_u24 v11, 4682, v10
    v_lshrrev_b32 v11, 16, v11
    v_mul_u32_u24 v12, 14, v11
    v_sub_u32 v12, v10, v12
    v_add_u32 v13, s45, v11
    v_mul_u32_u24 v14, 224, v13
    v_lshl_add_u32 v14, v12, 4, v14
    ds_read_b128 v[72:75], v14 offset:49152
    v_add_u32 v13, s46, v11
    v_mul_u32_u24 v13, 7168, v13
    v_lshl_add_u32 v13, v12, 4, v13
    v_add_u32 v98, s48, v13
    v_add_u32 v10, 320, v2
    v_mul_u32_u24 v11, 4682, v10
    v_lshrrev_b32 v11, 16, v11
    v_mul_u32_u24 v12, 14, v11
    v_sub_u32 v12, v10, v12
    v_add_u32 v13, s45, v11
    v_mul_u32_u24 v14, 224, v13
    v_lshl_add_u32 v14, v12, 4, v14
    ds_read_b128 v[76:79], v14 offset:49152
    v_add_u32 v13, s46, v11
    v_mul_u32_u24 v13, 7168, v13
    v_lshl_add_u32 v13, v12, 4, v13
    v_add_u32 v99, s48, v13
    v_add_u32 v10, 384, v2
    v_mul_u32_u24 v11, 4682, v10
    v_lshrrev_b32 v11, 16, v11
    v_mul_u32_u24 v12, 14, v11
    v_sub_u32 v12, v10, v12
    v_add_u32 v13, s45, v11
    v_mul_u32_u24 v14, 224, v13
    v_lshl_add_u32 v14, v12, 4, v14
    ds_read_b128 v[80:83], v14 offset:49152
    v_add_u32 v13, s46, v11
    v_mul_u32_u24 v13, 7168, v13
    v_lshl_add_u32 v13, v12, 4, v13
    v_add_u32 v100, s48, v13
    s_waitcnt lgkmcnt(12)
    global_store_dwordx4 v88, v[32:35], s[10:11]
    s_waitcnt lgkmcnt(11)
    global_store_dwordx4 v89, v[36:39], s[10:11]
    s_waitcnt lgkmcnt(10)
    global_store_dwordx4 v90, v[40:43], s[10:11]
    s_waitcnt lgkmcnt(9)
    global_store_dwordx4 v91, v[44:47], s[10:11]
    s_waitcnt lgkmcnt(8)
    global_store_dwordx4 v92, v[48:51], s[10:11]
    s_waitcnt lgkmcnt(7)
    global_store_dwordx4 v93, v[52:55], s[10:11]
    s_waitcnt lgkmcnt(6)
    global_store_dwordx4 v94, v[56:59], s[10:11]
    s_waitcnt lgkmcnt(5)
    global_store_dwordx4 v95, v[60:63], s[10:11]
    s_waitcnt lgkmcnt(4)
    global_store_dwordx4 v96, v[64:67], s[10:11]
    s_waitcnt lgkmcnt(3)
    global_store_dwordx4 v97, v[68:71], s[10:11]
    s_waitcnt lgkmcnt(2)
    global_store_dwordx4 v98, v[72:75], s[10:11]
    s_waitcnt lgkmcnt(1)
    global_store_dwordx4 v99, v[76:79], s[10:11]
    s_waitcnt lgkmcnt(0)
    global_store_dwordx4 v100, v[80:83], s[10:11]
L_g1_end_2:
    s_endpgm
L_g1_early_3:
    s_endpgm
.globl att_kernel
.p2align 8
.type att_kernel,@function
att_kernel:
    s_cmp_ge_u32 s2, 1024
    s_cbranch_scc1 L_att_early_7
    s_load_dwordx2 s[4:5], s[0:1], 72
    v_lshrrev_b32 v1, 6, v0
    v_and_b32 v2, 63, v0
    s_nop 0
    v_readfirstlane_b32 s3, v1
    s_lshr_b32 s6, s3, 1
    s_and_b32 s7, s3, 1
    s_and_b32 s9, s2, 7
    s_lshr_b32 s10, s2, 3
    s_lshl_b32 s9, s9, 7
    s_add_u32 s9, s9, s10
    s_lshl_b32 s8, s9, 1
    s_add_u32 s8, s8, s6
    s_load_dwordx2 s[60:61], s[0:1], 48
    s_load_dwordx2 s[62:63], s[0:1], 16
    s_waitcnt lgkmcnt(0)
    s_lshl_b32 s9, s7, 10
    v_lshl_add_u32 v3, v2, 4, s9
    v_add_u32 v4, 2048, v3
    v_add_u32 v5, 4096, v3
    s_sub_i32 s40, s8, 0
    s_max_i32 s10, s40, 0
    s_mul_i32 s10, s10, 6144
    s_add_u32 s10, s10, 4194304
    s_add_u32 s16, s4, s10
    s_addc_u32 s17, s5, 0
    s_sub_i32 s41, s8, 2
    s_max_i32 s10, s41, 0
    s_mul_i32 s10, s10, 6144
    s_add_u32 s10, s10, 4194304
    s_add_u32 s18, s4, s10
    s_addc_u32 s19, s5, 0
    s_sub_i32 s42, s8, 4
    s_max_i32 s10, s42, 0
    s_mul_i32 s10, s10, 6144
    s_add_u32 s10, s10, 4194304
    s_add_u32 s20, s4, s10
    s_addc_u32 s21, s5, 0
    s_sub_i32 s43, s8, 6
    s_max_i32 s10, s43, 0
    s_mul_i32 s10, s10, 6144
    s_add_u32 s10, s10, 4194304
    s_add_u32 s22, s4, s10
    s_addc_u32 s23, s5, 0
    s_sub_i32 s44, s8, 8
    s_max_i32 s10, s44, 0
    s_mul_i32 s10, s10, 6144
    s_add_u32 s10, s10, 4194304
    s_add_u32 s24, s4, s10
    s_addc_u32 s25, s5, 0
    s_sub_i32 s45, s8, 10
    s_max_i32 s10, s45, 0
    s_mul_i32 s10, s10, 6144
    s_add_u32 s10, s10, 4194304
    s_add_u32 s26, s4, s10
    s_addc_u32 s27, s5, 0
    s_sub_i32 s46, s8, 12
    s_max_i32 s10, s46, 0
    s_mul_i32 s10, s10, 6144
    s_add_u32 s10, s10, 4194304
    s_add_u32 s28, s4, s10
    s_addc_u32 s29, s5, 0
    s_sub_i32 s47, s8, 14
    s_max_i32 s10, s47, 0
    s_mul_i32 s10, s10, 6144
    s_add_u32 s10, s10, 4194304
    s_add_u32 s30, s4, s10
    s_addc_u32 s31, s5, 0
    global_load_dwordx4 v[8:11], v3, s[16:17]
    global_load_dwordx4 v[12:15], v4, s[16:17]
    global_load_dwordx4 v[16:19], v4, s[18:19]
    global_load_dwordx4 v[20:23], v4, s[20:21]
    global_load_dwordx4 v[24:27], v4, s[22:23]
    global_load_dwordx4 v[28:31], v4, s[24:25]
    global_load_dwordx4 v[32:35], v4, s[26:27]
    global_load_dwordx4 v[36:39], v4, s[28:29]
    global_load_dwordx4 v[40:43], v4, s[30:31]
    global_load_dwordx4 v[44:47], v5, s[16:17]
    global_load_dwordx4 v[48:51], v5, s[18:19]
    global_load_dwordx4 v[52:55], v5, s[20:21]
    global_load_dwordx4 v[56:59], v5, s[22:23]
    global_load_dwordx4 v[60:63], v5, s[24:25]
    global_load_dwordx4 v[64:67], v5, s[26:27]
    global_load_dwordx4 v[68:71], v5, s[28:29]
    global_load_dwordx4 v[72:75], v5, s[30:31]
    s_waitcnt vmcnt(15)
    v_dot2_f32_bf16 v76, v8, v12, 0
    v_dot2_f32_bf16 v76, v9, v13, v76
    v_dot2_f32_bf16 v76, v10, v14, v76
    v_dot2_f32_bf16 v76, v11, v15, v76
    s_waitcnt vmcnt(14)
    v_dot2_f32_bf16 v77, v8, v16, 0
    v_dot2_f32_bf16 v77, v9, v17, v77
    v_dot2_f32_bf16 v77, v10, v18, v77
    v_dot2_f32_bf16 v77, v11, v19, v77
    s_waitcnt vmcnt(13)
    v_dot2_f32_bf16 v78, v8, v20, 0
    v_dot2_f32_bf16 v78, v9, v21, v78
    v_dot2_f32_bf16 v78, v10, v22, v78
    v_dot2_f32_bf16 v78, v11, v23, v78
    s_waitcnt vmcnt(12)
    v_dot2_f32_bf16 v79, v8, v24, 0
    v_dot2_f32_bf16 v79, v9, v25, v79
    v_dot2_f32_bf16 v79, v10, v26, v79
    v_dot2_f32_bf16 v79, v11, v27, v79
    s_waitcnt vmcnt(11)
    v_dot2_f32_bf16 v80, v8, v28, 0
    v_dot2_f32_bf16 v80, v9, v29, v80
    v_dot2_f32_bf16 v80, v10, v30, v80
    v_dot2_f32_bf16 v80, v11, v31, v80
    s_waitcnt vmcnt(10)
    v_dot2_f32_bf16 v81, v8, v32, 0
    v_dot2_f32_bf16 v81, v9, v33, v81
    v_dot2_f32_bf16 v81, v10, v34, v81
    v_dot2_f32_bf16 v81, v11, v35, v81
    s_waitcnt vmcnt(9)
    v_dot2_f32_bf16 v82, v8, v36, 0
    v_dot2_f32_bf16 v82, v9, v37, v82
    v_dot2_f32_bf16 v82, v10, v38, v82
    v_dot2_f32_bf16 v82, v11, v39, v82
    s_waitcnt vmcnt(8)
    v_dot2_f32_bf16 v83, v8, v40, 0
    v_dot2_f32_bf16 v83, v9, v41, v83
    v_dot2_f32_bf16 v83, v10, v42, v83
    v_dot2_f32_bf16 v83, v11, v43, v83
    s_nop 1
    v_add_f32 v84, v76, v76 quad_perm:[1,0,3,2] row_mask:0xf bank_mask:0xf
    s_nop 1
    v_add_f32 v76, v84, v84 quad_perm:[2,3,0,1] row_mask:0xf bank_mask:0xf
    s_nop 1
    v_add_f32 v84, v77, v77 quad_perm:[1,0,3,2] row_mask:0xf bank_mask:0xf
    s_nop 1
    v_add_f32 v77, v84, v84 quad_perm:[2,3,0,1] row_mask:0xf bank_mask:0xf
    s_nop 1
    v_add_f32 v84, v78, v78 quad_perm:[1,0,3,2] row_mask:0xf bank_mask:0xf
    s_nop 1
    v_add_f32 v78, v84, v84 quad_perm:[2,3,0,1] row_mask:0xf bank_mask:0xf
    s_nop 1
    v_add_f32 v84, v79, v79 quad_perm:[1,0,3,2] row_mask:0xf bank_mask:0xf
    s_nop 1
    v_add_f32 v79, v84, v84 quad_perm:[2,3,0,1] row_mask:0xf bank_mask:0xf
    s_nop 1
    v_add_f32 v84, v80, v80 quad_perm:[1,0,3,2] row_mask:0xf bank_mask:0xf
    s_nop 1
    v_add_f32 v80, v84, v84 quad_perm:[2,3,0,1] row_mask:0xf bank_mask:0xf
    s_nop 1
    v_add_f32 v84, v81, v81 quad_perm:[1,0,3,2] row_mask:0xf bank_mask:0xf
    s_nop 1
    v_add_f32 v81, v84, v84 quad_perm:[2,3,0,1] row_mask:0xf bank_mask:0xf
    s_nop 1
    v_add_f32 v84, v82, v82 quad_perm:[1,0,3,2] row_mask:0xf bank_mask:0xf
    s_nop 1
    v_add_f32 v82, v84, v84 quad_perm:[2,3,0,1] row_mask:0xf bank_mask:0xf
    s_nop 1
    v_add_f32 v84, v83, v83 quad_perm:[1,0,3,2] row_mask:0xf bank_mask:0xf
    s_nop 1
    v_add_f32 v83, v84, v84 quad_perm:[2,3,0,1] row_mask:0xf bank_mask:0xf
    s_nop 1
    v_cvt_pk_bf16_f32 v76, v76, v76
    v_lshlrev_b32 v76, 16, v76
    v_mul_f32 v76, 0x3e3504f3, v76
    v_cvt_pk_bf16_f32 v76, v76, v76
    v_lshlrev_b32 v76, 16, v76
    v_cvt_pk_bf16_f32 v77, v77, v77
    v_lshlrev_b32 v77, 16, v77
    v_mul_f32 v77, 0x3e3504f3, v77
    v_cvt_pk_bf16_f32 v77, v77, v77
    v_lshlrev_b32 v77, 16, v77
    v_cvt_pk_bf16_f32 v78, v78, v78
    v_lshlrev_b32 v78, 16, v78
    v_mul_f32 v78, 0x3e3504f3, v78
    v_cvt_pk_bf16_f32 v78, v78, v78
    v_lshlrev_b32 v78, 16, v78
    v_cvt_pk_bf16_f32 v79, v79, v79
    v_lshlrev_b32 v79, 16, v79
    v_mul_f32 v79, 0x3e3504f3, v79
    v_cvt_pk_bf16_f32 v79, v79, v79
    v_lshlrev_b32 v79, 16, v79
    v_cvt_pk_bf16_f32 v80, v80, v80
    v_lshlrev_b32 v80, 16, v80
    v_mul_f32 v80, 0x3e3504f3, v80
    v_cvt_pk_bf16_f32 v80, v80, v80
    v_lshlrev_b32 v80, 16, v80
    v_cvt_pk_bf16_f32 v81, v81, v81
    v_lshlrev_b32 v81, 16, v81
    v_mul_f32 v81, 0x3e3504f3, v81
    v_cvt_pk_bf16_f32 v81, v81, v81
    v_lshlrev_b32 v81, 16, v81
    v_cvt_pk_bf16_f32 v82, v82, v82
    v_lshlrev_b32 v82, 16, v82
    v_mul_f32 v82, 0x3e3504f3, v82
    v_cvt_pk_bf16_f32 v82, v82, v82
    v_lshlrev_b32 v82, 16, v82
    v_cvt_pk_bf16_f32 v83, v83, v83
    v_lshlrev_b32 v83, 16, v83
    v_mul_f32 v83, 0x3e3504f3, v83
    v_cvt_pk_bf16_f32 v83, v83, v83
    v_lshlrev_b32 v83, 16, v83
    s_cmp_lt_i32 s41, 0
    s_cbranch_scc0 L_att_v_8
    v_mov_b32 v77, 0xce6e0000
L_att_v_8:
    s_cmp_lt_i32 s42, 0
    s_cbranch_scc0 L_att_v_9
    v_mov_b32 v78, 0xce6e0000
L_att_v_9:
    s_cmp_lt_i32 s43, 0
    s_cbranch_scc0 L_att_v_10
    v_mov_b32 v79, 0xce6e0000
L_att_v_10:
    s_cmp_lt_i32 s44, 0
    s_cbranch_scc0 L_att_v_11
    v_mov_b32 v80, 0xce6e0000
L_att_v_11:
    s_cmp_lt_i32 s45, 0
    s_cbranch_scc0 L_att_v_12
    v_mov_b32 v81, 0xce6e0000
L_att_v_12:
    s_cmp_lt_i32 s46, 0
    s_cbranch_scc0 L_att_v_13
    v_mov_b32 v82, 0xce6e0000
L_att_v_13:
    s_cmp_lt_i32 s47, 0
    s_cbranch_scc0 L_att_v_14
    v_mov_b32 v83, 0xce6e0000
L_att_v_14:
    v_max_f32 v84, v76, v77
    v_max_f32 v84, v84, v78
    v_max_f32 v84, v84, v79
    v_max_f32 v84, v84, v80
    v_max_f32 v84, v84, v81
    v_max_f32 v84, v84, v82
    v_max_f32 v84, v84, v83
    v_sub_f32 v76, v76, v84
    v_mul_f32 v76, 0x3fb8aa3b, v76
    v_exp_f32 v76, v76
    v_sub_f32 v77, v77, v84
    v_mul_f32 v77, 0x3fb8aa3b, v77
    v_exp_f32 v77, v77
    v_sub_f32 v78, v78, v84
    v_mul_f32 v78, 0x3fb8aa3b, v78
    v_exp_f32 v78, v78
    v_sub_f32 v79, v79, v84
    v_mul_f32 v79, 0x3fb8aa3b, v79
    v_exp_f32 v79, v79
    v_sub_f32 v80, v80, v84
    v_mul_f32 v80, 0x3fb8aa3b, v80
    v_exp_f32 v80, v80
    v_sub_f32 v81, v81, v84
    v_mul_f32 v81, 0x3fb8aa3b, v81
    v_exp_f32 v81, v81
    v_sub_f32 v82, v82, v84
    v_mul_f32 v82, 0x3fb8aa3b, v82
    v_exp_f32 v82, v82
    v_sub_f32 v83, v83, v84
    v_mul_f32 v83, 0x3fb8aa3b, v83
    v_exp_f32 v83, v83
    s_nop 0
    v_add_f32 v85, v76, v77
    v_add_f32 v85, v85, v78
    v_add_f32 v85, v85, v79
    v_add_f32 v85, v85, v80
    v_add_f32 v85, v85, v81
    v_add_f32 v85, v85, v82
    v_add_f32 v85, v85, v83
    v_rcp_f32 v86, v85
    s_nop 0
    v_mul_f32 v87, v76, v86
    v_fma_f32 v88, -v87, v85, v76
    v_fma_f32 v76, v88, v86, v87
    v_cvt_pk_bf16_f32 v76, v76, v76
    v_lshlrev_b32 v76, 16, v76
    v_mul_f32 v87, v77, v86
    v_fma_f32 v88, -v87, v85, v77
    v_fma_f32 v77, v88, v86, v87
    v_cvt_pk_bf16_f32 v77, v77, v77
    v_lshlrev_b32 v77, 16, v77
    v_mul_f32 v87, v78, v86
    v_fma_f32 v88, -v87, v85, v78
    v_fma_f32 v78, v88, v86, v87
    v_cvt_pk_bf16_f32 v78, v78, v78
    v_lshlrev_b32 v78, 16, v78
    v_mul_f32 v87, v79, v86
    v_fma_f32 v88, -v87, v85, v79
    v_fma_f32 v79, v88, v86, v87
    v_cvt_pk_bf16_f32 v79, v79, v79
    v_lshlrev_b32 v79, 16, v79
    v_mul_f32 v87, v80, v86
    v_fma_f32 v88, -v87, v85, v80
    v_fma_f32 v80, v88, v86, v87
    v_cvt_pk_bf16_f32 v80, v80, v80
    v_lshlrev_b32 v80, 16, v80
    v_mul_f32 v87, v81, v86
    v_fma_f32 v88, -v87, v85, v81
    v_fma_f32 v81, v88, v86, v87
    v_cvt_pk_bf16_f32 v81, v81, v81
    v_lshlrev_b32 v81, 16, v81
    v_mul_f32 v87, v82, v86
    v_fma_f32 v88, -v87, v85, v82
    v_fma_f32 v82, v88, v86, v87
    v_cvt_pk_bf16_f32 v82, v82, v82
    v_lshlrev_b32 v82, 16, v82
    v_mul_f32 v87, v83, v86
    v_fma_f32 v88, -v87, v85, v83
    v_fma_f32 v83, v88, v86, v87
    v_cvt_pk_bf16_f32 v83, v83, v83
    v_lshlrev_b32 v83, 16, v83
    s_waitcnt vmcnt(0)
    v_lshlrev_b32 v84, 16, v44
    v_and_b32 v85, 0xffff0000, v44
    v_mul_f32 v88, v76, v84
    v_mul_f32 v89, v76, v85
    v_lshlrev_b32 v84, 16, v45
    v_and_b32 v85, 0xffff0000, v45
    v_mul_f32 v90, v76, v84
    v_mul_f32 v91, v76, v85
    v_lshlrev_b32 v84, 16, v46
    v_and_b32 v85, 0xffff0000, v46
    v_mul_f32 v92, v76, v84
    v_mul_f32 v93, v76, v85
    v_lshlrev_b32 v84, 16, v47
    v_and_b32 v85, 0xffff0000, v47
    v_mul_f32 v94, v76, v84
    v_mul_f32 v95, v76, v85
    v_lshlrev_b32 v84, 16, v48
    v_and_b32 v85, 0xffff0000, v48
    v_fmac_f32 v88, v77, v84
    v_fmac_f32 v89, v77, v85
    v_lshlrev_b32 v84, 16, v49
    v_and_b32 v85, 0xffff0000, v49
    v_fmac_f32 v90, v77, v84
    v_fmac_f32 v91, v77, v85
    v_lshlrev_b32 v84, 16, v50
    v_and_b32 v85, 0xffff0000, v50
    v_fmac_f32 v92, v77, v84
    v_fmac_f32 v93, v77, v85
    v_lshlrev_b32 v84, 16, v51
    v_and_b32 v85, 0xffff0000, v51
    v_fmac_f32 v94, v77, v84
    v_fmac_f32 v95, v77, v85
    v_lshlrev_b32 v84, 16, v52
    v_and_b32 v85, 0xffff0000, v52
    v_fmac_f32 v88, v78, v84
    v_fmac_f32 v89, v78, v85
    v_lshlrev_b32 v84, 16, v53
    v_and_b32 v85, 0xffff0000, v53
    v_fmac_f32 v90, v78, v84
    v_fmac_f32 v91, v78, v85
    v_lshlrev_b32 v84, 16, v54
    v_and_b32 v85, 0xffff0000, v54
    v_fmac_f32 v92, v78, v84
    v_fmac_f32 v93, v78, v85
    v_lshlrev_b32 v84, 16, v55
    v_and_b32 v85, 0xffff0000, v55
    v_fmac_f32 v94, v78, v84
    v_fmac_f32 v95, v78, v85
    v_lshlrev_b32 v84, 16, v56
    v_and_b32 v85, 0xffff0000, v56
    v_fmac_f32 v88, v79, v84
    v_fmac_f32 v89, v79, v85
    v_lshlrev_b32 v84, 16, v57
    v_and_b32 v85, 0xffff0000, v57
    v_fmac_f32 v90, v79, v84
    v_fmac_f32 v91, v79, v85
    v_lshlrev_b32 v84, 16, v58
    v_and_b32 v85, 0xffff0000, v58
    v_fmac_f32 v92, v79, v84
    v_fmac_f32 v93, v79, v85
    v_lshlrev_b32 v84, 16, v59
    v_and_b32 v85, 0xffff0000, v59
    v_fmac_f32 v94, v79, v84
    v_fmac_f32 v95, v79, v85
    v_lshlrev_b32 v84, 16, v60
    v_and_b32 v85, 0xffff0000, v60
    v_fmac_f32 v88, v80, v84
    v_fmac_f32 v89, v80, v85
    v_lshlrev_b32 v84, 16, v61
    v_and_b32 v85, 0xffff0000, v61
    v_fmac_f32 v90, v80, v84
    v_fmac_f32 v91, v80, v85
    v_lshlrev_b32 v84, 16, v62
    v_and_b32 v85, 0xffff0000, v62
    v_fmac_f32 v92, v80, v84
    v_fmac_f32 v93, v80, v85
    v_lshlrev_b32 v84, 16, v63
    v_and_b32 v85, 0xffff0000, v63
    v_fmac_f32 v94, v80, v84
    v_fmac_f32 v95, v80, v85
    v_lshlrev_b32 v84, 16, v64
    v_and_b32 v85, 0xffff0000, v64
    v_fmac_f32 v88, v81, v84
    v_fmac_f32 v89, v81, v85
    v_lshlrev_b32 v84, 16, v65
    v_and_b32 v85, 0xffff0000, v65
    v_fmac_f32 v90, v81, v84
    v_fmac_f32 v91, v81, v85
    v_lshlrev_b32 v84, 16, v66
    v_and_b32 v85, 0xffff0000, v66
    v_fmac_f32 v92, v81, v84
    v_fmac_f32 v93, v81, v85
    v_lshlrev_b32 v84, 16, v67
    v_and_b32 v85, 0xffff0000, v67
    v_fmac_f32 v94, v81, v84
    v_fmac_f32 v95, v81, v85
    v_lshlrev_b32 v84, 16, v68
    v_and_b32 v85, 0xffff0000, v68
    v_fmac_f32 v88, v82, v84
    v_fmac_f32 v89, v82, v85
    v_lshlrev_b32 v84, 16, v69
    v_and_b32 v85, 0xffff0000, v69
    v_fmac_f32 v90, v82, v84
    v_fmac_f32 v91, v82, v85
    v_lshlrev_b32 v84, 16, v70
    v_and_b32 v85, 0xffff0000, v70
    v_fmac_f32 v92, v82, v84
    v_fmac_f32 v93, v82, v85
    v_lshlrev_b32 v84, 16, v71
    v_and_b32 v85, 0xffff0000, v71
    v_fmac_f32 v94, v82, v84
    v_fmac_f32 v95, v82, v85
    v_lshlrev_b32 v84, 16, v72
    v_and_b32 v85, 0xffff0000, v72
    v_fmac_f32 v88, v83, v84
    v_fmac_f32 v89, v83, v85
    v_lshlrev_b32 v84, 16, v73
    v_and_b32 v85, 0xffff0000, v73
    v_fmac_f32 v90, v83, v84
    v_fmac_f32 v91, v83, v85
    v_lshlrev_b32 v84, 16, v74
    v_and_b32 v85, 0xffff0000, v74
    v_fmac_f32 v92, v83, v84
    v_fmac_f32 v93, v83, v85
    v_lshlrev_b32 v84, 16, v75
    v_and_b32 v85, 0xffff0000, v75
    v_fmac_f32 v94, v83, v84
    v_fmac_f32 v95, v83, v85
    v_cvt_pk_bf16_f32 v8, v88, v89
    v_cvt_pk_bf16_f32 v9, v90, v91
    v_cvt_pk_bf16_f32 v10, v92, v93
    v_cvt_pk_bf16_f32 v11, v94, v95
    s_lshl_b32 s10, s8, 11
    s_add_u32 s10, s10, 31457280
    s_add_u32 s10, s4, s10
    s_addc_u32 s11, s5, 0
    global_store_dwordx4 v3, v[8:11], s[10:11]
    s_mul_i32 s12, s2, 7168
    s_lshl_b32 s13, s2, 11
    v_lshlrev_b32 v90, 4, v0
    v_add_u32 v91, s12, v90
    v_add_u32 v92, s13, v90
    v_cmp_gt_u32 vcc, 192, v0
    global_load_dwordx4 v[96:99], v91, s[60:61]
    s_and_saveexec_b64 s[14:15], vcc
    v_add_u32 v93, 4096, v91
    global_load_dwordx4 v[100:103], v93, s[60:61]
    v_cmp_gt_u32 vcc, 128, v0
    s_and_b64 exec, exec, vcc
    global_load_dwordx4 v[104:107], v92, s[62:63]
    s_mov_b64 exec, s[14:15]
L_att_early_7:
    s_endpgm
.globl gemm2_kernel
.p2align 8
.type gemm2_kernel,@function
gemm2_kernel:
    s_cmp_ge_u32 s2, 256
    s_cbranch_scc1 L_g2_early_15
    s_load_dwordx2 s[4:5], s[0:1], 16
    s_load_dwordx2 s[6:7], s[0:1], 48
    s_load_dwordx2 s[8:9], s[0:1], 0
    s_load_dwordx2 s[10:11], s[0:1], 72
    s_load_dwordx2 s[12:13], s[0:1], 56
    s_and_b32 s28, s2, 7
    s_lshr_b32 s29, s2, 3
    s_lshr_b32 s23, s28, 1
    s_lshl_b32 s23, s23, 2
    s_lshr_b32 s30, s29, 3
    s_add_u32 s23, s23, s30
    s_and_b32 s24, s28, 1
    s_lshl_b32 s24, s24, 3
    s_and_b32 s30, s29, 7
    s_add_u32 s24, s24, s30
    v_lshrrev_b32 v1, 6, v0
    v_and_b32 v2, 63, v0
    s_nop 0
    v_readfirstlane_b32 s20, v1
    s_cmp_ge_u32 s20, 4
    s_cbranch_scc1 L_g2_loader_16
    s_and_b32 s21, s20, 1
    s_lshr_b32 s22, s20, 1
    v_lshrrev_b32 v3, 4, v2
    v_and_b32 v4, 15, v2
    v_bfe_u32 v5, v2, 2, 2
    v_and_b32 v6, 3, v2
    v_xor_b32 v9, v3, v4
    v_lshlrev_b32 v9, 4, v9
    v_lshl_add_u32 v9, v4, 8, v9
    s_lshl_b32 s28, s21, 14
    v_add_u32 v58, s28, v9
    v_xor_b32 v59, 64, v58
    v_xor_b32 v60, 128, v58
    v_xor_b32 v61, 192, v58
    v_lshl_add_u32 v9, v3, 3, v5
    v_lshlrev_b32 v9, 7, v9
    v_lshl_add_u32 v9, v6, 3, v9
    v_lshrrev_b32 v10, 1, v5
    v_and_b32 v11, 1, v3
    v_lshl_or_b32 v10, v11, 1, v10
    s_lshl_b32 s28, s22, 1
    s_add_u32 s29, s28, 0
    v_xor_b32 v11, s29, v10
    v_lshl_add_u32 v49, v11, 5, v9
    s_add_u32 s29, s28, 1
    v_xor_b32 v11, s29, v10
    v_lshl_add_u32 v50, v11, 5, v9
    v_mov_b32 v64, 0
    v_mov_b32 v65, 0
    v_mov_b32 v66, 0
    v_mov_b32 v67, 0
    v_mov_b32 v68, 0
    v_mov_b32 v69, 0
    v_mov_b32 v70, 0
    v_mov_b32 v71, 0
    v_mov_b32 v72, 0
    v_mov_b32 v73, 0
    v_mov_b32 v74, 0
    v_mov_b32 v75, 0
    v_mov_b32 v76, 0
    v_mov_b32 v77, 0
    v_mov_b32 v78, 0
    v_mov_b32 v79, 0
    v_mov_b32 v80, 0
    v_mov_b32 v81, 0
    v_mov_b32 v82, 0
    v_mov_b32 v83, 0
    v_mov_b32 v84, 0
    v_mov_b32 v85, 0
    v_mov_b32 v86, 0
    v_mov_b32 v87, 0
    v_mov_b32 v88, 0
    v_mov_b32 v89, 0
    v_mov_b32 v90, 0
    v_mov_b32 v91, 0
    v_mov_b32 v92, 0
    v_mov_b32 v93, 0
    v_mov_b32 v94, 0
    v_mov_b32 v95, 0
    v_mov_b32 v96, 0
    v_mov_b32 v97, 0
    v_mov_b32 v98, 0
    v_mov_b32 v99, 0
    v_mov_b32 v100, 0
    v_mov_b32 v101, 0
    v_mov_b32 v102, 0
    v_mov_b32 v103, 0
    v_mov_b32 v104, 0
    v_mov_b32 v105, 0
    v_mov_b32 v106, 0
    v_mov_b32 v107, 0
    v_mov_b32 v108, 0
    v_mov_b32 v109, 0
    v_mov_b32 v110, 0
    v_mov_b32 v111, 0
    v_mov_b32 v112, 0
    v_mov_b32 v113, 0
    v_mov_b32 v114, 0
    v_mov_b32 v115, 0
    v_mov_b32 v116, 0
    v_mov_b32 v117, 0
    v_mov_b32 v118, 0
    v_mov_b32 v119, 0
    v_mov_b32 v120, 0
    v_mov_b32 v121, 0
    v_mov_b32 v122, 0
    v_mov_b32 v123, 0
    v_mov_b32 v124, 0
    v_mov_b32 v125, 0
    v_mov_b32 v126, 0
    v_mov_b32 v127, 0
    s_waitcnt lgkmcnt(0)
    s_mov_b32 s27, 2
L_g2_ca_17:
    s_barrier
    ds_read_b128 v[0:3], v58 offset:0
    ds_read_b128 v[4:7], v58 offset:4096
    ds_read_b128 v[8:11], v58 offset:8192
    ds_read_b128 v[12:15], v58 offset:12288
    ds_read_b64_tr_b16 v[32:33], v49 offset:32768
    ds_read_b64_tr_b16 v[34:35], v49 offset:33280
    ds_read_b64_tr_b16 v[36:37], v50 offset:32768
    ds_read_b64_tr_b16 v[38:39], v50 offset:33280
    ds_read_b128 v[16:19], v59 offset:0
    ds_read_b128 v[20:23], v59 offset:4096
    ds_read_b128 v[24:27], v59 offset:8192
    ds_read_b128 v[28:31], v59 offset:12288
    ds_read_b64_tr_b16 v[40:41], v49 offset:36864
    ds_read_b64_tr_b16 v[42:43], v49 offset:37376
    ds_read_b64_tr_b16 v[44:45], v50 offset:36864
    ds_read_b64_tr_b16 v[46:47], v50 offset:37376
    s_waitcnt lgkmcnt(8)
    v_mfma_f32_16x16x32_bf16 v[64:67], v[32:35], v[0:3], v[64:67]
    v_mfma_f32_16x16x32_bf16 v[68:71], v[32:35], v[4:7], v[68:71]
    v_mfma_f32_16x16x32_bf16 v[72:75], v[32:35], v[8:11], v[72:75]
    v_mfma_f32_16x16x32_bf16 v[76:79], v[32:35], v[12:15], v[76:79]
    v_mfma_f32_16x16x32_bf16 v[80:83], v[36:39], v[0:3], v[80:83]
    v_mfma_f32_16x16x32_bf16 v[84:87], v[36:39], v[4:7], v[84:87]
    v_mfma_f32_16x16x32_bf16 v[88:91], v[36:39], v[8:11], v[88:91]
    v_mfma_f32_16x16x32_bf16 v[92:95], v[36:39], v[12:15], v[92:95]
    ds_read_b128 v[0:3], v60 offset:0
    ds_read_b128 v[4:7], v60 offset:4096
    ds_read_b128 v[8:11], v60 offset:8192
    ds_read_b128 v[12:15], v60 offset:12288
    ds_read_b64_tr_b16 v[32:33], v49 offset:40960
    ds_read_b64_tr_b16 v[34:35], v49 offset:41472
    ds_read_b64_tr_b16 v[36:37], v50 offset:40960
    ds_read_b64_tr_b16 v[38:39], v50 offset:41472
    s_waitcnt lgkmcnt(8)
    v_mfma_f32_16x16x32_bf16 v[64:67], v[40:43], v[16:19], v[64:67]
    v_mfma_f32_16x16x32_bf16 v[68:71], v[40:43], v[20:23], v[68:71]
    v_mfma_f32_16x16x32_bf16 v[72:75], v[40:43], v[24:27], v[72:75]
    v_mfma_f32_16x16x32_bf16 v[76:79], v[40:43], v[28:31], v[76:79]
    v_mfma_f32_16x16x32_bf16 v[80:83], v[44:47], v[16:19], v[80:83]
    v_mfma_f32_16x16x32_bf16 v[84:87], v[44:47], v[20:23], v[84:87]
    v_mfma_f32_16x16x32_bf16 v[88:91], v[44:47], v[24:27], v[88:91]
    v_mfma_f32_16x16x32_bf16 v[92:95], v[44:47], v[28:31], v[92:95]
    ds_read_b128 v[16:19], v61 offset:0
    ds_read_b128 v[20:23], v61 offset:4096
    ds_read_b128 v[24:27], v61 offset:8192
    ds_read_b128 v[28:31], v61 offset:12288
    ds_read_b64_tr_b16 v[40:41], v49 offset:45056
    ds_read_b64_tr_b16 v[42:43], v49 offset:45568
    ds_read_b64_tr_b16 v[44:45], v50 offset:45056
    ds_read_b64_tr_b16 v[46:47], v50 offset:45568
    s_waitcnt lgkmcnt(8)
    v_mfma_f32_16x16x32_bf16 v[64:67], v[32:35], v[0:3], v[64:67]
    v_mfma_f32_16x16x32_bf16 v[68:71], v[32:35], v[4:7], v[68:71]
    v_mfma_f32_16x16x32_bf16 v[72:75], v[32:35], v[8:11], v[72:75]
    v_mfma_f32_16x16x32_bf16 v[76:79], v[32:35], v[12:15], v[76:79]
    v_mfma_f32_16x16x32_bf16 v[80:83], v[36:39], v[0:3], v[80:83]
    v_mfma_f32_16x16x32_bf16 v[84:87], v[36:39], v[4:7], v[84:87]
    v_mfma_f32_16x16x32_bf16 v[88:91], v[36:39], v[8:11], v[88:91]
    v_mfma_f32_16x16x32_bf16 v[92:95], v[36:39], v[12:15], v[92:95]
    v_add_u32 v58, 49152, v58
    v_add_u32 v59, 49152, v59
    v_add_u32 v60, 49152, v60
    v_add_u32 v61, 49152, v61
    v_add_u32 v49, 49152, v49
    v_add_u32 v50, 49152, v50
    s_waitcnt lgkmcnt(0)
    v_mfma_f32_16x16x32_bf16 v[64:67], v[40:43], v[16:19], v[64:67]
    v_mfma_f32_16x16x32_bf16 v[68:71], v[40:43], v[20:23], v[68:71]
    v_mfma_f32_16x16x32_bf16 v[72:75], v[40:43], v[24:27], v[72:75]
    v_mfma_f32_16x16x32_bf16 v[76:79], v[40:43], v[28:31], v[76:79]
    v_mfma_f32_16x16x32_bf16 v[80:83], v[44:47], v[16:19], v[80:83]
    v_mfma_f32_16x16x32_bf16 v[84:87], v[44:47], v[20:23], v[84:87]
    v_mfma_f32_16x16x32_bf16 v[88:91], v[44:47], v[24:27], v[88:91]
    v_mfma_f32_16x16x32_bf16 v[92:95], v[44:47], v[28:31], v[92:95]
    s_barrier
    ds_read_b128 v[0:3], v58 offset:0
    ds_read_b128 v[4:7], v58 offset:4096
    ds_read_b128 v[8:11], v58 offset:8192
    ds_read_b128 v[12:15], v58 offset:12288
    ds_read_b64_tr_b16 v[32:33], v49 offset:32768
    ds_read_b64_tr_b16 v[34:35], v49 offset:33280
    ds_read_b64_tr_b16 v[36:37], v50 offset:32768
    ds_read_b64_tr_b16 v[38:39], v50 offset:33280
    ds_read_b128 v[16:19], v59 offset:0
    ds_read_b128 v[20:23], v59 offset:4096
    ds_read_b128 v[24:27], v59 offset:8192
    ds_read_b128 v[28:31], v59 offset:12288
    ds_read_b64_tr_b16 v[40:41], v49 offset:36864
    ds_read_b64_tr_b16 v[42:43], v49 offset:37376
    ds_read_b64_tr_b16 v[44:45], v50 offset:36864
    ds_read_b64_tr_b16 v[46:47], v50 offset:37376
    s_waitcnt lgkmcnt(8)
    v_mfma_f32_16x16x32_bf16 v[64:67], v[32:35], v[0:3], v[64:67]
    v_mfma_f32_16x16x32_bf16 v[68:71], v[32:35], v[4:7], v[68:71]
    v_mfma_f32_16x16x32_bf16 v[72:75], v[32:35], v[8:11], v[72:75]
    v_mfma_f32_16x16x32_bf16 v[76:79], v[32:35], v[12:15], v[76:79]
    v_mfma_f32_16x16x32_bf16 v[80:83], v[36:39], v[0:3], v[80:83]
    v_mfma_f32_16x16x32_bf16 v[84:87], v[36:39], v[4:7], v[84:87]
    v_mfma_f32_16x16x32_bf16 v[88:91], v[36:39], v[8:11], v[88:91]
    v_mfma_f32_16x16x32_bf16 v[92:95], v[36:39], v[12:15], v[92:95]
    ds_read_b128 v[0:3], v60 offset:0
    ds_read_b128 v[4:7], v60 offset:4096
    ds_read_b128 v[8:11], v60 offset:8192
    ds_read_b128 v[12:15], v60 offset:12288
    ds_read_b64_tr_b16 v[32:33], v49 offset:40960
    ds_read_b64_tr_b16 v[34:35], v49 offset:41472
    ds_read_b64_tr_b16 v[36:37], v50 offset:40960
    ds_read_b64_tr_b16 v[38:39], v50 offset:41472
    s_waitcnt lgkmcnt(8)
    v_mfma_f32_16x16x32_bf16 v[64:67], v[40:43], v[16:19], v[64:67]
    v_mfma_f32_16x16x32_bf16 v[68:71], v[40:43], v[20:23], v[68:71]
    v_mfma_f32_16x16x32_bf16 v[72:75], v[40:43], v[24:27], v[72:75]
    v_mfma_f32_16x16x32_bf16 v[76:79], v[40:43], v[28:31], v[76:79]
    v_mfma_f32_16x16x32_bf16 v[80:83], v[44:47], v[16:19], v[80:83]
    v_mfma_f32_16x16x32_bf16 v[84:87], v[44:47], v[20:23], v[84:87]
    v_mfma_f32_16x16x32_bf16 v[88:91], v[44:47], v[24:27], v[88:91]
    v_mfma_f32_16x16x32_bf16 v[92:95], v[44:47], v[28:31], v[92:95]
    ds_read_b128 v[16:19], v61 offset:0
    ds_read_b128 v[20:23], v61 offset:4096
    ds_read_b128 v[24:27], v61 offset:8192
    ds_read_b128 v[28:31], v61 offset:12288
    ds_read_b64_tr_b16 v[40:41], v49 offset:45056
    ds_read_b64_tr_b16 v[42:43], v49 offset:45568
    ds_read_b64_tr_b16 v[44:45], v50 offset:45056
    ds_read_b64_tr_b16 v[46:47], v50 offset:45568
    s_waitcnt lgkmcnt(8)
    v_mfma_f32_16x16x32_bf16 v[64:67], v[32:35], v[0:3], v[64:67]
    v_mfma_f32_16x16x32_bf16 v[68:71], v[32:35], v[4:7], v[68:71]
    v_mfma_f32_16x16x32_bf16 v[72:75], v[32:35], v[8:11], v[72:75]
    v_mfma_f32_16x16x32_bf16 v[76:79], v[32:35], v[12:15], v[76:79]
    v_mfma_f32_16x16x32_bf16 v[80:83], v[36:39], v[0:3], v[80:83]
    v_mfma_f32_16x16x32_bf16 v[84:87], v[36:39], v[4:7], v[84:87]
    v_mfma_f32_16x16x32_bf16 v[88:91], v[36:39], v[8:11], v[88:91]
    v_mfma_f32_16x16x32_bf16 v[92:95], v[36:39], v[12:15], v[92:95]
    v_add_u32 v58, 49152, v58
    v_add_u32 v59, 49152, v59
    v_add_u32 v60, 49152, v60
    v_add_u32 v61, 49152, v61
    v_add_u32 v49, 49152, v49
    v_add_u32 v50, 49152, v50
    s_waitcnt lgkmcnt(0)
    v_mfma_f32_16x16x32_bf16 v[64:67], v[40:43], v[16:19], v[64:67]
    v_mfma_f32_16x16x32_bf16 v[68:71], v[40:43], v[20:23], v[68:71]
    v_mfma_f32_16x16x32_bf16 v[72:75], v[40:43], v[24:27], v[72:75]
    v_mfma_f32_16x16x32_bf16 v[76:79], v[40:43], v[28:31], v[76:79]
    v_mfma_f32_16x16x32_bf16 v[80:83], v[44:47], v[16:19], v[80:83]
    v_mfma_f32_16x16x32_bf16 v[84:87], v[44:47], v[20:23], v[84:87]
    v_mfma_f32_16x16x32_bf16 v[88:91], v[44:47], v[24:27], v[88:91]
    v_mfma_f32_16x16x32_bf16 v[92:95], v[44:47], v[28:31], v[92:95]
    s_barrier
    ds_read_b128 v[0:3], v58 offset:0
    ds_read_b128 v[4:7], v58 offset:4096
    ds_read_b128 v[8:11], v58 offset:8192
    ds_read_b128 v[12:15], v58 offset:12288
    ds_read_b64_tr_b16 v[32:33], v49 offset:32768
    ds_read_b64_tr_b16 v[34:35], v49 offset:33280
    ds_read_b64_tr_b16 v[36:37], v50 offset:32768
    ds_read_b64_tr_b16 v[38:39], v50 offset:33280
    ds_read_b128 v[16:19], v59 offset:0
    ds_read_b128 v[20:23], v59 offset:4096
    ds_read_b128 v[24:27], v59 offset:8192
    ds_read_b128 v[28:31], v59 offset:12288
    ds_read_b64_tr_b16 v[40:41], v49 offset:36864
    ds_read_b64_tr_b16 v[42:43], v49 offset:37376
    ds_read_b64_tr_b16 v[44:45], v50 offset:36864
    ds_read_b64_tr_b16 v[46:47], v50 offset:37376
    s_waitcnt lgkmcnt(8)
    v_mfma_f32_16x16x32_bf16 v[64:67], v[32:35], v[0:3], v[64:67]
    v_mfma_f32_16x16x32_bf16 v[68:71], v[32:35], v[4:7], v[68:71]
    v_mfma_f32_16x16x32_bf16 v[72:75], v[32:35], v[8:11], v[72:75]
    v_mfma_f32_16x16x32_bf16 v[76:79], v[32:35], v[12:15], v[76:79]
    v_mfma_f32_16x16x32_bf16 v[80:83], v[36:39], v[0:3], v[80:83]
    v_mfma_f32_16x16x32_bf16 v[84:87], v[36:39], v[4:7], v[84:87]
    v_mfma_f32_16x16x32_bf16 v[88:91], v[36:39], v[8:11], v[88:91]
    v_mfma_f32_16x16x32_bf16 v[92:95], v[36:39], v[12:15], v[92:95]
    ds_read_b128 v[0:3], v60 offset:0
    ds_read_b128 v[4:7], v60 offset:4096
    ds_read_b128 v[8:11], v60 offset:8192
    ds_read_b128 v[12:15], v60 offset:12288
    ds_read_b64_tr_b16 v[32:33], v49 offset:40960
    ds_read_b64_tr_b16 v[34:35], v49 offset:41472
    ds_read_b64_tr_b16 v[36:37], v50 offset:40960
    ds_read_b64_tr_b16 v[38:39], v50 offset:41472
    s_waitcnt lgkmcnt(8)
    v_mfma_f32_16x16x32_bf16 v[64:67], v[40:43], v[16:19], v[64:67]
    v_mfma_f32_16x16x32_bf16 v[68:71], v[40:43], v[20:23], v[68:71]
    v_mfma_f32_16x16x32_bf16 v[72:75], v[40:43], v[24:27], v[72:75]
    v_mfma_f32_16x16x32_bf16 v[76:79], v[40:43], v[28:31], v[76:79]
    v_mfma_f32_16x16x32_bf16 v[80:83], v[44:47], v[16:19], v[80:83]
    v_mfma_f32_16x16x32_bf16 v[84:87], v[44:47], v[20:23], v[84:87]
    v_mfma_f32_16x16x32_bf16 v[88:91], v[44:47], v[24:27], v[88:91]
    v_mfma_f32_16x16x32_bf16 v[92:95], v[44:47], v[28:31], v[92:95]
    ds_read_b128 v[16:19], v61 offset:0
    ds_read_b128 v[20:23], v61 offset:4096
    ds_read_b128 v[24:27], v61 offset:8192
    ds_read_b128 v[28:31], v61 offset:12288
    ds_read_b64_tr_b16 v[40:41], v49 offset:45056
    ds_read_b64_tr_b16 v[42:43], v49 offset:45568
    ds_read_b64_tr_b16 v[44:45], v50 offset:45056
    ds_read_b64_tr_b16 v[46:47], v50 offset:45568
    s_waitcnt lgkmcnt(8)
    v_mfma_f32_16x16x32_bf16 v[64:67], v[32:35], v[0:3], v[64:67]
    v_mfma_f32_16x16x32_bf16 v[68:71], v[32:35], v[4:7], v[68:71]
    v_mfma_f32_16x16x32_bf16 v[72:75], v[32:35], v[8:11], v[72:75]
    v_mfma_f32_16x16x32_bf16 v[76:79], v[32:35], v[12:15], v[76:79]
    v_mfma_f32_16x16x32_bf16 v[80:83], v[36:39], v[0:3], v[80:83]
    v_mfma_f32_16x16x32_bf16 v[84:87], v[36:39], v[4:7], v[84:87]
    v_mfma_f32_16x16x32_bf16 v[88:91], v[36:39], v[8:11], v[88:91]
    v_mfma_f32_16x16x32_bf16 v[92:95], v[36:39], v[12:15], v[92:95]
    v_add_u32 v58, 4294868992, v58
    v_add_u32 v59, 4294868992, v59
    v_add_u32 v60, 4294868992, v60
    v_add_u32 v61, 4294868992, v61
    v_add_u32 v49, 4294868992, v49
    v_add_u32 v50, 4294868992, v50
    s_waitcnt lgkmcnt(0)
    v_mfma_f32_16x16x32_bf16 v[64:67], v[40:43], v[16:19], v[64:67]
    v_mfma_f32_16x16x32_bf16 v[68:71], v[40:43], v[20:23], v[68:71]
    v_mfma_f32_16x16x32_bf16 v[72:75], v[40:43], v[24:27], v[72:75]
    v_mfma_f32_16x16x32_bf16 v[76:79], v[40:43], v[28:31], v[76:79]
    v_mfma_f32_16x16x32_bf16 v[80:83], v[44:47], v[16:19], v[80:83]
    v_mfma_f32_16x16x32_bf16 v[84:87], v[44:47], v[20:23], v[84:87]
    v_mfma_f32_16x16x32_bf16 v[88:91], v[44:47], v[24:27], v[88:91]
    v_mfma_f32_16x16x32_bf16 v[92:95], v[44:47], v[28:31], v[92:95]
    s_sub_u32 s27, s27, 1
    s_cmp_lg_u32 s27, 0
    s_cbranch_scc1 L_g2_ca_17
    s_barrier
    ds_read_b128 v[0:3], v58 offset:0
    ds_read_b128 v[4:7], v58 offset:4096
    ds_read_b128 v[8:11], v58 offset:8192
    ds_read_b128 v[12:15], v58 offset:12288
    ds_read_b64_tr_b16 v[32:33], v49 offset:32768
    ds_read_b64_tr_b16 v[34:35], v49 offset:33280
    ds_read_b64_tr_b16 v[36:37], v50 offset:32768
    ds_read_b64_tr_b16 v[38:39], v50 offset:33280
    ds_read_b128 v[16:19], v59 offset:0
    ds_read_b128 v[20:23], v59 offset:4096
    ds_read_b128 v[24:27], v59 offset:8192
    ds_read_b128 v[28:31], v59 offset:12288
    ds_read_b64_tr_b16 v[40:41], v49 offset:36864
    ds_read_b64_tr_b16 v[42:43], v49 offset:37376
    ds_read_b64_tr_b16 v[44:45], v50 offset:36864
    ds_read_b64_tr_b16 v[46:47], v50 offset:37376
    s_waitcnt lgkmcnt(8)
    v_mfma_f32_16x16x32_bf16 v[64:67], v[32:35], v[0:3], v[64:67]
    v_mfma_f32_16x16x32_bf16 v[68:71], v[32:35], v[4:7], v[68:71]
    v_mfma_f32_16x16x32_bf16 v[72:75], v[32:35], v[8:11], v[72:75]
    v_mfma_f32_16x16x32_bf16 v[76:79], v[32:35], v[12:15], v[76:79]
    v_mfma_f32_16x16x32_bf16 v[80:83], v[36:39], v[0:3], v[80:83]
    v_mfma_f32_16x16x32_bf16 v[84:87], v[36:39], v[4:7], v[84:87]
    v_mfma_f32_16x16x32_bf16 v[88:91], v[36:39], v[8:11], v[88:91]
    v_mfma_f32_16x16x32_bf16 v[92:95], v[36:39], v[12:15], v[92:95]
    ds_read_b128 v[0:3], v60 offset:0
    ds_read_b128 v[4:7], v60 offset:4096
    ds_read_b128 v[8:11], v60 offset:8192
    ds_read_b128 v[12:15], v60 offset:12288
    ds_read_b64_tr_b16 v[32:33], v49 offset:40960
    ds_read_b64_tr_b16 v[34:35], v49 offset:41472
    ds_read_b64_tr_b16 v[36:37], v50 offset:40960
    ds_read_b64_tr_b16 v[38:39], v50 offset:41472
    s_waitcnt lgkmcnt(8)
    v_mfma_f32_16x16x32_bf16 v[64:67], v[40:43], v[16:19], v[64:67]
    v_mfma_f32_16x16x32_bf16 v[68:71], v[40:43], v[20:23], v[68:71]
    v_mfma_f32_16x16x32_bf16 v[72:75], v[40:43], v[24:27], v[72:75]
    v_mfma_f32_16x16x32_bf16 v[76:79], v[40:43], v[28:31], v[76:79]
    v_mfma_f32_16x16x32_bf16 v[80:83], v[44:47], v[16:19], v[80:83]
    v_mfma_f32_16x16x32_bf16 v[84:87], v[44:47], v[20:23], v[84:87]
    v_mfma_f32_16x16x32_bf16 v[88:91], v[44:47], v[24:27], v[88:91]
    v_mfma_f32_16x16x32_bf16 v[92:95], v[44:47], v[28:31], v[92:95]
    ds_read_b128 v[16:19], v61 offset:0
    ds_read_b128 v[20:23], v61 offset:4096
    ds_read_b128 v[24:27], v61 offset:8192
    ds_read_b128 v[28:31], v61 offset:12288
    ds_read_b64_tr_b16 v[40:41], v49 offset:45056
    ds_read_b64_tr_b16 v[42:43], v49 offset:45568
    ds_read_b64_tr_b16 v[44:45], v50 offset:45056
    ds_read_b64_tr_b16 v[46:47], v50 offset:45568
    s_waitcnt lgkmcnt(8)
    v_mfma_f32_16x16x32_bf16 v[64:67], v[32:35], v[0:3], v[64:67]
    v_mfma_f32_16x16x32_bf16 v[68:71], v[32:35], v[4:7], v[68:71]
    v_mfma_f32_16x16x32_bf16 v[72:75], v[32:35], v[8:11], v[72:75]
    v_mfma_f32_16x16x32_bf16 v[76:79], v[32:35], v[12:15], v[76:79]
    v_mfma_f32_16x16x32_bf16 v[80:83], v[36:39], v[0:3], v[80:83]
    v_mfma_f32_16x16x32_bf16 v[84:87], v[36:39], v[4:7], v[84:87]
    v_mfma_f32_16x16x32_bf16 v[88:91], v[36:39], v[8:11], v[88:91]
    v_mfma_f32_16x16x32_bf16 v[92:95], v[36:39], v[12:15], v[92:95]
    v_add_u32 v58, 49152, v58
    v_add_u32 v59, 49152, v59
    v_add_u32 v60, 49152, v60
    v_add_u32 v61, 49152, v61
    v_add_u32 v49, 49152, v49
    v_add_u32 v50, 49152, v50
    s_waitcnt lgkmcnt(0)
    v_mfma_f32_16x16x32_bf16 v[64:67], v[40:43], v[16:19], v[64:67]
    v_mfma_f32_16x16x32_bf16 v[68:71], v[40:43], v[20:23], v[68:71]
    v_mfma_f32_16x16x32_bf16 v[72:75], v[40:43], v[24:27], v[72:75]
    v_mfma_f32_16x16x32_bf16 v[76:79], v[40:43], v[28:31], v[76:79]
    v_mfma_f32_16x16x32_bf16 v[80:83], v[44:47], v[16:19], v[80:83]
    v_mfma_f32_16x16x32_bf16 v[84:87], v[44:47], v[20:23], v[84:87]
    v_mfma_f32_16x16x32_bf16 v[88:91], v[44:47], v[24:27], v[88:91]
    v_mfma_f32_16x16x32_bf16 v[92:95], v[44:47], v[28:31], v[92:95]
    s_barrier
    ds_read_b128 v[0:3], v58 offset:0
    ds_read_b128 v[4:7], v58 offset:4096
    ds_read_b128 v[8:11], v58 offset:8192
    ds_read_b128 v[12:15], v58 offset:12288
    ds_read_b64_tr_b16 v[32:33], v49 offset:32768
    ds_read_b64_tr_b16 v[34:35], v49 offset:33280
    ds_read_b64_tr_b16 v[36:37], v50 offset:32768
    ds_read_b64_tr_b16 v[38:39], v50 offset:33280
    ds_read_b128 v[16:19], v59 offset:0
    ds_read_b128 v[20:23], v59 offset:4096
    ds_read_b128 v[24:27], v59 offset:8192
    ds_read_b128 v[28:31], v59 offset:12288
    ds_read_b64_tr_b16 v[40:41], v49 offset:36864
    ds_read_b64_tr_b16 v[42:43], v49 offset:37376
    ds_read_b64_tr_b16 v[44:45], v50 offset:36864
    ds_read_b64_tr_b16 v[46:47], v50 offset:37376
    s_waitcnt lgkmcnt(8)
    v_mfma_f32_16x16x32_bf16 v[64:67], v[32:35], v[0:3], v[64:67]
    v_mfma_f32_16x16x32_bf16 v[68:71], v[32:35], v[4:7], v[68:71]
    v_mfma_f32_16x16x32_bf16 v[72:75], v[32:35], v[8:11], v[72:75]
    v_mfma_f32_16x16x32_bf16 v[76:79], v[32:35], v[12:15], v[76:79]
    v_mfma_f32_16x16x32_bf16 v[80:83], v[36:39], v[0:3], v[80:83]
    v_mfma_f32_16x16x32_bf16 v[84:87], v[36:39], v[4:7], v[84:87]
    v_mfma_f32_16x16x32_bf16 v[88:91], v[36:39], v[8:11], v[88:91]
    v_mfma_f32_16x16x32_bf16 v[92:95], v[36:39], v[12:15], v[92:95]
    ds_read_b128 v[0:3], v60 offset:0
    ds_read_b128 v[4:7], v60 offset:4096
    ds_read_b128 v[8:11], v60 offset:8192
    ds_read_b128 v[12:15], v60 offset:12288
    ds_read_b64_tr_b16 v[32:33], v49 offset:40960
    ds_read_b64_tr_b16 v[34:35], v49 offset:41472
    ds_read_b64_tr_b16 v[36:37], v50 offset:40960
    ds_read_b64_tr_b16 v[38:39], v50 offset:41472
    s_waitcnt lgkmcnt(8)
    v_mfma_f32_16x16x32_bf16 v[64:67], v[40:43], v[16:19], v[64:67]
    v_mfma_f32_16x16x32_bf16 v[68:71], v[40:43], v[20:23], v[68:71]
    v_mfma_f32_16x16x32_bf16 v[72:75], v[40:43], v[24:27], v[72:75]
    v_mfma_f32_16x16x32_bf16 v[76:79], v[40:43], v[28:31], v[76:79]
    v_mfma_f32_16x16x32_bf16 v[80:83], v[44:47], v[16:19], v[80:83]
    v_mfma_f32_16x16x32_bf16 v[84:87], v[44:47], v[20:23], v[84:87]
    v_mfma_f32_16x16x32_bf16 v[88:91], v[44:47], v[24:27], v[88:91]
    v_mfma_f32_16x16x32_bf16 v[92:95], v[44:47], v[28:31], v[92:95]
    ds_read_b128 v[16:19], v61 offset:0
    ds_read_b128 v[20:23], v61 offset:4096
    ds_read_b128 v[24:27], v61 offset:8192
    ds_read_b128 v[28:31], v61 offset:12288
    ds_read_b64_tr_b16 v[40:41], v49 offset:45056
    ds_read_b64_tr_b16 v[42:43], v49 offset:45568
    ds_read_b64_tr_b16 v[44:45], v50 offset:45056
    ds_read_b64_tr_b16 v[46:47], v50 offset:45568
    s_waitcnt lgkmcnt(8)
    v_mfma_f32_16x16x32_bf16 v[64:67], v[32:35], v[0:3], v[64:67]
    v_mfma_f32_16x16x32_bf16 v[68:71], v[32:35], v[4:7], v[68:71]
    v_mfma_f32_16x16x32_bf16 v[72:75], v[32:35], v[8:11], v[72:75]
    v_mfma_f32_16x16x32_bf16 v[76:79], v[32:35], v[12:15], v[76:79]
    v_mfma_f32_16x16x32_bf16 v[80:83], v[36:39], v[0:3], v[80:83]
    v_mfma_f32_16x16x32_bf16 v[84:87], v[36:39], v[4:7], v[84:87]
    v_mfma_f32_16x16x32_bf16 v[88:91], v[36:39], v[8:11], v[88:91]
    v_mfma_f32_16x16x32_bf16 v[92:95], v[36:39], v[12:15], v[92:95]
    v_add_u32 v58, 49152, v58
    v_add_u32 v59, 49152, v59
    v_add_u32 v60, 49152, v60
    v_add_u32 v61, 49152, v61
    v_add_u32 v49, 49152, v49
    v_add_u32 v50, 49152, v50
    s_waitcnt lgkmcnt(0)
    v_mfma_f32_16x16x32_bf16 v[64:67], v[40:43], v[16:19], v[64:67]
    v_mfma_f32_16x16x32_bf16 v[68:71], v[40:43], v[20:23], v[68:71]
    v_mfma_f32_16x16x32_bf16 v[72:75], v[40:43], v[24:27], v[72:75]
    v_mfma_f32_16x16x32_bf16 v[76:79], v[40:43], v[28:31], v[76:79]
    v_mfma_f32_16x16x32_bf16 v[80:83], v[44:47], v[16:19], v[80:83]
    v_mfma_f32_16x16x32_bf16 v[84:87], v[44:47], v[20:23], v[84:87]
    v_mfma_f32_16x16x32_bf16 v[88:91], v[44:47], v[24:27], v[88:91]
    v_mfma_f32_16x16x32_bf16 v[92:95], v[44:47], v[28:31], v[92:95]
    s_barrier
    ds_read_b128 v[0:3], v58 offset:0
    ds_read_b128 v[4:7], v58 offset:4096
    ds_read_b128 v[8:11], v58 offset:8192
    ds_read_b128 v[12:15], v58 offset:12288
    ds_read_b64_tr_b16 v[32:33], v49 offset:32768
    ds_read_b64_tr_b16 v[34:35], v49 offset:33280
    ds_read_b64_tr_b16 v[36:37], v50 offset:32768
    ds_read_b64_tr_b16 v[38:39], v50 offset:33280
    ds_read_b128 v[16:19], v59 offset:0
    ds_read_b128 v[20:23], v59 offset:4096
    ds_read_b128 v[24:27], v59 offset:8192
    ds_read_b128 v[28:31], v59 offset:12288
    ds_read_b64_tr_b16 v[40:41], v49 offset:36864
    ds_read_b64_tr_b16 v[42:43], v49 offset:37376
    ds_read_b64_tr_b16 v[44:45], v50 offset:36864
    ds_read_b64_tr_b16 v[46:47], v50 offset:37376
    s_waitcnt lgkmcnt(8)
    v_mfma_f32_16x16x32_bf16 v[96:99], v[32:35], v[0:3], v[96:99]
    v_mfma_f32_16x16x32_bf16 v[100:103], v[32:35], v[4:7], v[100:103]
    v_mfma_f32_16x16x32_bf16 v[104:107], v[32:35], v[8:11], v[104:107]
    v_mfma_f32_16x16x32_bf16 v[108:111], v[32:35], v[12:15], v[108:111]
    v_mfma_f32_16x16x32_bf16 v[112:115], v[36:39], v[0:3], v[112:115]
    v_mfma_f32_16x16x32_bf16 v[116:119], v[36:39], v[4:7], v[116:119]
    v_mfma_f32_16x16x32_bf16 v[120:123], v[36:39], v[8:11], v[120:123]
    v_mfma_f32_16x16x32_bf16 v[124:127], v[36:39], v[12:15], v[124:127]
    ds_read_b128 v[0:3], v60 offset:0
    ds_read_b128 v[4:7], v60 offset:4096
    ds_read_b128 v[8:11], v60 offset:8192
    ds_read_b128 v[12:15], v60 offset:12288
    ds_read_b64_tr_b16 v[32:33], v49 offset:40960
    ds_read_b64_tr_b16 v[34:35], v49 offset:41472
    ds_read_b64_tr_b16 v[36:37], v50 offset:40960
    ds_read_b64_tr_b16 v[38:39], v50 offset:41472
    s_waitcnt lgkmcnt(8)
    v_mfma_f32_16x16x32_bf16 v[96:99], v[40:43], v[16:19], v[96:99]
    v_mfma_f32_16x16x32_bf16 v[100:103], v[40:43], v[20:23], v[100:103]
    v_mfma_f32_16x16x32_bf16 v[104:107], v[40:43], v[24:27], v[104:107]
    v_mfma_f32_16x16x32_bf16 v[108:111], v[40:43], v[28:31], v[108:111]
    v_mfma_f32_16x16x32_bf16 v[112:115], v[44:47], v[16:19], v[112:115]
    v_mfma_f32_16x16x32_bf16 v[116:119], v[44:47], v[20:23], v[116:119]
    v_mfma_f32_16x16x32_bf16 v[120:123], v[44:47], v[24:27], v[120:123]
    v_mfma_f32_16x16x32_bf16 v[124:127], v[44:47], v[28:31], v[124:127]
    ds_read_b128 v[16:19], v61 offset:0
    ds_read_b128 v[20:23], v61 offset:4096
    ds_read_b128 v[24:27], v61 offset:8192
    ds_read_b128 v[28:31], v61 offset:12288
    ds_read_b64_tr_b16 v[40:41], v49 offset:45056
    ds_read_b64_tr_b16 v[42:43], v49 offset:45568
    ds_read_b64_tr_b16 v[44:45], v50 offset:45056
    ds_read_b64_tr_b16 v[46:47], v50 offset:45568
    s_waitcnt lgkmcnt(8)
    v_mfma_f32_16x16x32_bf16 v[96:99], v[32:35], v[0:3], v[96:99]
    v_mfma_f32_16x16x32_bf16 v[100:103], v[32:35], v[4:7], v[100:103]
    v_mfma_f32_16x16x32_bf16 v[104:107], v[32:35], v[8:11], v[104:107]
    v_mfma_f32_16x16x32_bf16 v[108:111], v[32:35], v[12:15], v[108:111]
    v_mfma_f32_16x16x32_bf16 v[112:115], v[36:39], v[0:3], v[112:115]
    v_mfma_f32_16x16x32_bf16 v[116:119], v[36:39], v[4:7], v[116:119]
    v_mfma_f32_16x16x32_bf16 v[120:123], v[36:39], v[8:11], v[120:123]
    v_mfma_f32_16x16x32_bf16 v[124:127], v[36:39], v[12:15], v[124:127]
    v_add_u32 v58, 4294868992, v58
    v_add_u32 v59, 4294868992, v59
    v_add_u32 v60, 4294868992, v60
    v_add_u32 v61, 4294868992, v61
    v_add_u32 v49, 4294868992, v49
    v_add_u32 v50, 4294868992, v50
    s_waitcnt lgkmcnt(0)
    v_mfma_f32_16x16x32_bf16 v[96:99], v[40:43], v[16:19], v[96:99]
    v_mfma_f32_16x16x32_bf16 v[100:103], v[40:43], v[20:23], v[100:103]
    v_mfma_f32_16x16x32_bf16 v[104:107], v[40:43], v[24:27], v[104:107]
    v_mfma_f32_16x16x32_bf16 v[108:111], v[40:43], v[28:31], v[108:111]
    v_mfma_f32_16x16x32_bf16 v[112:115], v[44:47], v[16:19], v[112:115]
    v_mfma_f32_16x16x32_bf16 v[116:119], v[44:47], v[20:23], v[116:119]
    v_mfma_f32_16x16x32_bf16 v[120:123], v[44:47], v[24:27], v[120:123]
    v_mfma_f32_16x16x32_bf16 v[124:127], v[44:47], v[28:31], v[124:127]
    s_mov_b32 s27, 9
L_g2_cc_18:
    s_barrier
    ds_read_b128 v[0:3], v58 offset:0
    ds_read_b128 v[4:7], v58 offset:4096
    ds_read_b128 v[8:11], v58 offset:8192
    ds_read_b128 v[12:15], v58 offset:12288
    ds_read_b64_tr_b16 v[32:33], v49 offset:32768
    ds_read_b64_tr_b16 v[34:35], v49 offset:33280
    ds_read_b64_tr_b16 v[36:37], v50 offset:32768
    ds_read_b64_tr_b16 v[38:39], v50 offset:33280
    ds_read_b128 v[16:19], v59 offset:0
    ds_read_b128 v[20:23], v59 offset:4096
    ds_read_b128 v[24:27], v59 offset:8192
    ds_read_b128 v[28:31], v59 offset:12288
    ds_read_b64_tr_b16 v[40:41], v49 offset:36864
    ds_read_b64_tr_b16 v[42:43], v49 offset:37376
    ds_read_b64_tr_b16 v[44:45], v50 offset:36864
    ds_read_b64_tr_b16 v[46:47], v50 offset:37376
    s_waitcnt lgkmcnt(8)
    v_mfma_f32_16x16x32_bf16 v[96:99], v[32:35], v[0:3], v[96:99]
    v_mfma_f32_16x16x32_bf16 v[100:103], v[32:35], v[4:7], v[100:103]
    v_mfma_f32_16x16x32_bf16 v[104:107], v[32:35], v[8:11], v[104:107]
    v_mfma_f32_16x16x32_bf16 v[108:111], v[32:35], v[12:15], v[108:111]
    v_mfma_f32_16x16x32_bf16 v[112:115], v[36:39], v[0:3], v[112:115]
    v_mfma_f32_16x16x32_bf16 v[116:119], v[36:39], v[4:7], v[116:119]
    v_mfma_f32_16x16x32_bf16 v[120:123], v[36:39], v[8:11], v[120:123]
    v_mfma_f32_16x16x32_bf16 v[124:127], v[36:39], v[12:15], v[124:127]
    ds_read_b128 v[0:3], v60 offset:0
    ds_read_b128 v[4:7], v60 offset:4096
    ds_read_b128 v[8:11], v60 offset:8192
    ds_read_b128 v[12:15], v60 offset:12288
    ds_read_b64_tr_b16 v[32:33], v49 offset:40960
    ds_read_b64_tr_b16 v[34:35], v49 offset:41472
    ds_read_b64_tr_b16 v[36:37], v50 offset:40960
    ds_read_b64_tr_b16 v[38:39], v50 offset:41472
    s_waitcnt lgkmcnt(8)
    v_mfma_f32_16x16x32_bf16 v[96:99], v[40:43], v[16:19], v[96:99]
    v_mfma_f32_16x16x32_bf16 v[100:103], v[40:43], v[20:23], v[100:103]
    v_mfma_f32_16x16x32_bf16 v[104:107], v[40:43], v[24:27], v[104:107]
    v_mfma_f32_16x16x32_bf16 v[108:111], v[40:43], v[28:31], v[108:111]
    v_mfma_f32_16x16x32_bf16 v[112:115], v[44:47], v[16:19], v[112:115]
    v_mfma_f32_16x16x32_bf16 v[116:119], v[44:47], v[20:23], v[116:119]
    v_mfma_f32_16x16x32_bf16 v[120:123], v[44:47], v[24:27], v[120:123]
    v_mfma_f32_16x16x32_bf16 v[124:127], v[44:47], v[28:31], v[124:127]
    ds_read_b128 v[16:19], v61 offset:0
    ds_read_b128 v[20:23], v61 offset:4096
    ds_read_b128 v[24:27], v61 offset:8192
    ds_read_b128 v[28:31], v61 offset:12288
    ds_read_b64_tr_b16 v[40:41], v49 offset:45056
    ds_read_b64_tr_b16 v[42:43], v49 offset:45568
    ds_read_b64_tr_b16 v[44:45], v50 offset:45056
    ds_read_b64_tr_b16 v[46:47], v50 offset:45568
    s_waitcnt lgkmcnt(8)
    v_mfma_f32_16x16x32_bf16 v[96:99], v[32:35], v[0:3], v[96:99]
    v_mfma_f32_16x16x32_bf16 v[100:103], v[32:35], v[4:7], v[100:103]
    v_mfma_f32_16x16x32_bf16 v[104:107], v[32:35], v[8:11], v[104:107]
    v_mfma_f32_16x16x32_bf16 v[108:111], v[32:35], v[12:15], v[108:111]
    v_mfma_f32_16x16x32_bf16 v[112:115], v[36:39], v[0:3], v[112:115]
    v_mfma_f32_16x16x32_bf16 v[116:119], v[36:39], v[4:7], v[116:119]
    v_mfma_f32_16x16x32_bf16 v[120:123], v[36:39], v[8:11], v[120:123]
    v_mfma_f32_16x16x32_bf16 v[124:127], v[36:39], v[12:15], v[124:127]
    v_add_u32 v58, 49152, v58
    v_add_u32 v59, 49152, v59
    v_add_u32 v60, 49152, v60
    v_add_u32 v61, 49152, v61
    v_add_u32 v49, 49152, v49
    v_add_u32 v50, 49152, v50
    s_waitcnt lgkmcnt(0)
    v_mfma_f32_16x16x32_bf16 v[96:99], v[40:43], v[16:19], v[96:99]
    v_mfma_f32_16x16x32_bf16 v[100:103], v[40:43], v[20:23], v[100:103]
    v_mfma_f32_16x16x32_bf16 v[104:107], v[40:43], v[24:27], v[104:107]
    v_mfma_f32_16x16x32_bf16 v[108:111], v[40:43], v[28:31], v[108:111]
    v_mfma_f32_16x16x32_bf16 v[112:115], v[44:47], v[16:19], v[112:115]
    v_mfma_f32_16x16x32_bf16 v[116:119], v[44:47], v[20:23], v[116:119]
    v_mfma_f32_16x16x32_bf16 v[120:123], v[44:47], v[24:27], v[120:123]
    v_mfma_f32_16x16x32_bf16 v[124:127], v[44:47], v[28:31], v[124:127]
    s_barrier
    ds_read_b128 v[0:3], v58 offset:0
    ds_read_b128 v[4:7], v58 offset:4096
    ds_read_b128 v[8:11], v58 offset:8192
    ds_read_b128 v[12:15], v58 offset:12288
    ds_read_b64_tr_b16 v[32:33], v49 offset:32768
    ds_read_b64_tr_b16 v[34:35], v49 offset:33280
    ds_read_b64_tr_b16 v[36:37], v50 offset:32768
    ds_read_b64_tr_b16 v[38:39], v50 offset:33280
    ds_read_b128 v[16:19], v59 offset:0
    ds_read_b128 v[20:23], v59 offset:4096
    ds_read_b128 v[24:27], v59 offset:8192
    ds_read_b128 v[28:31], v59 offset:12288
    ds_read_b64_tr_b16 v[40:41], v49 offset:36864
    ds_read_b64_tr_b16 v[42:43], v49 offset:37376
    ds_read_b64_tr_b16 v[44:45], v50 offset:36864
    ds_read_b64_tr_b16 v[46:47], v50 offset:37376
    s_waitcnt lgkmcnt(8)
    v_mfma_f32_16x16x32_bf16 v[96:99], v[32:35], v[0:3], v[96:99]
    v_mfma_f32_16x16x32_bf16 v[100:103], v[32:35], v[4:7], v[100:103]
    v_mfma_f32_16x16x32_bf16 v[104:107], v[32:35], v[8:11], v[104:107]
    v_mfma_f32_16x16x32_bf16 v[108:111], v[32:35], v[12:15], v[108:111]
    v_mfma_f32_16x16x32_bf16 v[112:115], v[36:39], v[0:3], v[112:115]
    v_mfma_f32_16x16x32_bf16 v[116:119], v[36:39], v[4:7], v[116:119]
    v_mfma_f32_16x16x32_bf16 v[120:123], v[36:39], v[8:11], v[120:123]
    v_mfma_f32_16x16x32_bf16 v[124:127], v[36:39], v[12:15], v[124:127]
    ds_read_b128 v[0:3], v60 offset:0
    ds_read_b128 v[4:7], v60 offset:4096
    ds_read_b128 v[8:11], v60 offset:8192
    ds_read_b128 v[12:15], v60 offset:12288
    ds_read_b64_tr_b16 v[32:33], v49 offset:40960
    ds_read_b64_tr_b16 v[34:35], v49 offset:41472
    ds_read_b64_tr_b16 v[36:37], v50 offset:40960
    ds_read_b64_tr_b16 v[38:39], v50 offset:41472
    s_waitcnt lgkmcnt(8)
    v_mfma_f32_16x16x32_bf16 v[96:99], v[40:43], v[16:19], v[96:99]
    v_mfma_f32_16x16x32_bf16 v[100:103], v[40:43], v[20:23], v[100:103]
    v_mfma_f32_16x16x32_bf16 v[104:107], v[40:43], v[24:27], v[104:107]
    v_mfma_f32_16x16x32_bf16 v[108:111], v[40:43], v[28:31], v[108:111]
    v_mfma_f32_16x16x32_bf16 v[112:115], v[44:47], v[16:19], v[112:115]
    v_mfma_f32_16x16x32_bf16 v[116:119], v[44:47], v[20:23], v[116:119]
    v_mfma_f32_16x16x32_bf16 v[120:123], v[44:47], v[24:27], v[120:123]
    v_mfma_f32_16x16x32_bf16 v[124:127], v[44:47], v[28:31], v[124:127]
    ds_read_b128 v[16:19], v61 offset:0
    ds_read_b128 v[20:23], v61 offset:4096
    ds_read_b128 v[24:27], v61 offset:8192
    ds_read_b128 v[28:31], v61 offset:12288
    ds_read_b64_tr_b16 v[40:41], v49 offset:45056
    ds_read_b64_tr_b16 v[42:43], v49 offset:45568
    ds_read_b64_tr_b16 v[44:45], v50 offset:45056
    ds_read_b64_tr_b16 v[46:47], v50 offset:45568
    s_waitcnt lgkmcnt(8)
    v_mfma_f32_16x16x32_bf16 v[96:99], v[32:35], v[0:3], v[96:99]
    v_mfma_f32_16x16x32_bf16 v[100:103], v[32:35], v[4:7], v[100:103]
    v_mfma_f32_16x16x32_bf16 v[104:107], v[32:35], v[8:11], v[104:107]
    v_mfma_f32_16x16x32_bf16 v[108:111], v[32:35], v[12:15], v[108:111]
    v_mfma_f32_16x16x32_bf16 v[112:115], v[36:39], v[0:3], v[112:115]
    v_mfma_f32_16x16x32_bf16 v[116:119], v[36:39], v[4:7], v[116:119]
    v_mfma_f32_16x16x32_bf16 v[120:123], v[36:39], v[8:11], v[120:123]
    v_mfma_f32_16x16x32_bf16 v[124:127], v[36:39], v[12:15], v[124:127]
    v_add_u32 v58, 49152, v58
    v_add_u32 v59, 49152, v59
    v_add_u32 v60, 49152, v60
    v_add_u32 v61, 49152, v61
    v_add_u32 v49, 49152, v49
    v_add_u32 v50, 49152, v50
    s_waitcnt lgkmcnt(0)
    v_mfma_f32_16x16x32_bf16 v[96:99], v[40:43], v[16:19], v[96:99]
    v_mfma_f32_16x16x32_bf16 v[100:103], v[40:43], v[20:23], v[100:103]
    v_mfma_f32_16x16x32_bf16 v[104:107], v[40:43], v[24:27], v[104:107]
    v_mfma_f32_16x16x32_bf16 v[108:111], v[40:43], v[28:31], v[108:111]
    v_mfma_f32_16x16x32_bf16 v[112:115], v[44:47], v[16:19], v[112:115]
    v_mfma_f32_16x16x32_bf16 v[116:119], v[44:47], v[20:23], v[116:119]
    v_mfma_f32_16x16x32_bf16 v[120:123], v[44:47], v[24:27], v[120:123]
    v_mfma_f32_16x16x32_bf16 v[124:127], v[44:47], v[28:31], v[124:127]
    s_barrier
    ds_read_b128 v[0:3], v58 offset:0
    ds_read_b128 v[4:7], v58 offset:4096
    ds_read_b128 v[8:11], v58 offset:8192
    ds_read_b128 v[12:15], v58 offset:12288
    ds_read_b64_tr_b16 v[32:33], v49 offset:32768
    ds_read_b64_tr_b16 v[34:35], v49 offset:33280
    ds_read_b64_tr_b16 v[36:37], v50 offset:32768
    ds_read_b64_tr_b16 v[38:39], v50 offset:33280
    ds_read_b128 v[16:19], v59 offset:0
    ds_read_b128 v[20:23], v59 offset:4096
    ds_read_b128 v[24:27], v59 offset:8192
    ds_read_b128 v[28:31], v59 offset:12288
    ds_read_b64_tr_b16 v[40:41], v49 offset:36864
    ds_read_b64_tr_b16 v[42:43], v49 offset:37376
    ds_read_b64_tr_b16 v[44:45], v50 offset:36864
    ds_read_b64_tr_b16 v[46:47], v50 offset:37376
    s_waitcnt lgkmcnt(8)
    v_mfma_f32_16x16x32_bf16 v[96:99], v[32:35], v[0:3], v[96:99]
    v_mfma_f32_16x16x32_bf16 v[100:103], v[32:35], v[4:7], v[100:103]
    v_mfma_f32_16x16x32_bf16 v[104:107], v[32:35], v[8:11], v[104:107]
    v_mfma_f32_16x16x32_bf16 v[108:111], v[32:35], v[12:15], v[108:111]
    v_mfma_f32_16x16x32_bf16 v[112:115], v[36:39], v[0:3], v[112:115]
    v_mfma_f32_16x16x32_bf16 v[116:119], v[36:39], v[4:7], v[116:119]
    v_mfma_f32_16x16x32_bf16 v[120:123], v[36:39], v[8:11], v[120:123]
    v_mfma_f32_16x16x32_bf16 v[124:127], v[36:39], v[12:15], v[124:127]
    ds_read_b128 v[0:3], v60 offset:0
    ds_read_b128 v[4:7], v60 offset:4096
    ds_read_b128 v[8:11], v60 offset:8192
    ds_read_b128 v[12:15], v60 offset:12288
    ds_read_b64_tr_b16 v[32:33], v49 offset:40960
    ds_read_b64_tr_b16 v[34:35], v49 offset:41472
    ds_read_b64_tr_b16 v[36:37], v50 offset:40960
    ds_read_b64_tr_b16 v[38:39], v50 offset:41472
    s_waitcnt lgkmcnt(8)
    v_mfma_f32_16x16x32_bf16 v[96:99], v[40:43], v[16:19], v[96:99]
    v_mfma_f32_16x16x32_bf16 v[100:103], v[40:43], v[20:23], v[100:103]
    v_mfma_f32_16x16x32_bf16 v[104:107], v[40:43], v[24:27], v[104:107]
    v_mfma_f32_16x16x32_bf16 v[108:111], v[40:43], v[28:31], v[108:111]
    v_mfma_f32_16x16x32_bf16 v[112:115], v[44:47], v[16:19], v[112:115]
    v_mfma_f32_16x16x32_bf16 v[116:119], v[44:47], v[20:23], v[116:119]
    v_mfma_f32_16x16x32_bf16 v[120:123], v[44:47], v[24:27], v[120:123]
    v_mfma_f32_16x16x32_bf16 v[124:127], v[44:47], v[28:31], v[124:127]
    ds_read_b128 v[16:19], v61 offset:0
    ds_read_b128 v[20:23], v61 offset:4096
    ds_read_b128 v[24:27], v61 offset:8192
    ds_read_b128 v[28:31], v61 offset:12288
    ds_read_b64_tr_b16 v[40:41], v49 offset:45056
    ds_read_b64_tr_b16 v[42:43], v49 offset:45568
    ds_read_b64_tr_b16 v[44:45], v50 offset:45056
    ds_read_b64_tr_b16 v[46:47], v50 offset:45568
    s_waitcnt lgkmcnt(8)
    v_mfma_f32_16x16x32_bf16 v[96:99], v[32:35], v[0:3], v[96:99]
    v_mfma_f32_16x16x32_bf16 v[100:103], v[32:35], v[4:7], v[100:103]
    v_mfma_f32_16x16x32_bf16 v[104:107], v[32:35], v[8:11], v[104:107]
    v_mfma_f32_16x16x32_bf16 v[108:111], v[32:35], v[12:15], v[108:111]
    v_mfma_f32_16x16x32_bf16 v[112:115], v[36:39], v[0:3], v[112:115]
    v_mfma_f32_16x16x32_bf16 v[116:119], v[36:39], v[4:7], v[116:119]
    v_mfma_f32_16x16x32_bf16 v[120:123], v[36:39], v[8:11], v[120:123]
    v_mfma_f32_16x16x32_bf16 v[124:127], v[36:39], v[12:15], v[124:127]
    v_add_u32 v58, 4294868992, v58
    v_add_u32 v59, 4294868992, v59
    v_add_u32 v60, 4294868992, v60
    v_add_u32 v61, 4294868992, v61
    v_add_u32 v49, 4294868992, v49
    v_add_u32 v50, 4294868992, v50
    s_waitcnt lgkmcnt(0)
    v_mfma_f32_16x16x32_bf16 v[96:99], v[40:43], v[16:19], v[96:99]
    v_mfma_f32_16x16x32_bf16 v[100:103], v[40:43], v[20:23], v[100:103]
    v_mfma_f32_16x16x32_bf16 v[104:107], v[40:43], v[24:27], v[104:107]
    v_mfma_f32_16x16x32_bf16 v[108:111], v[40:43], v[28:31], v[108:111]
    v_mfma_f32_16x16x32_bf16 v[112:115], v[44:47], v[16:19], v[112:115]
    v_mfma_f32_16x16x32_bf16 v[116:119], v[44:47], v[20:23], v[116:119]
    v_mfma_f32_16x16x32_bf16 v[120:123], v[44:47], v[24:27], v[120:123]
    v_mfma_f32_16x16x32_bf16 v[124:127], v[44:47], v[28:31], v[124:127]
    s_sub_u32 s27, s27, 1
    s_cmp_lg_u32 s27, 0
    s_cbranch_scc1 L_g2_cc_18
    s_nop 15
    v_mbcnt_lo_u32_b32 v2, -1, 0
    v_mbcnt_hi_u32_b32 v2, -1, v2
    v_lshrrev_b32 v3, 4, v2
    v_and_b32 v4, 15, v2
    s_lshl_b32 s28, s23, 7
    s_lshl_b32 s29, s21, 6
    s_add_u32 s28, s28, s29
    v_add_u32 v5, s28, v4
    v_lshlrev_b32 v5, 11, v5
    v_lshl_add_u32 v5, v3, 3, v5
    s_lshl_b32 s28, s24, 7
    s_lshl_b32 s29, s22, 6
    s_add_u32 s28, s28, s29
    v_add_u32 v5, s28, v5
    v_add_u32 v6, 0, v5
    global_load_dwordx2 v[8:9], v6, s[8:9] offset:0
    global_load_dwordx2 v[16:17], v6, s[8:9] offset:32
    v_add_u32 v6, 32768, v5
    global_load_dwordx2 v[10:11], v6, s[8:9] offset:0
    global_load_dwordx2 v[18:19], v6, s[8:9] offset:32
    v_add_u32 v6, 65536, v5
    global_load_dwordx2 v[12:13], v6, s[8:9] offset:0
    global_load_dwordx2 v[20:21], v6, s[8:9] offset:32
    v_add_u32 v6, 98304, v5
    global_load_dwordx2 v[14:15], v6, s[8:9] offset:0
    global_load_dwordx2 v[22:23], v6, s[8:9] offset:32
    v_add_u32 v6, 0, v5
    s_waitcnt vmcnt(7)
    v_cvt_pk_bf16_f32 v32, v96, v96
    v_cvt_pk_bf16_f32 v33, v97, v97
    v_cvt_pk_bf16_f32 v34, v98, v98
    v_cvt_pk_bf16_f32 v35, v99, v99
    v_lshlrev_b32 v32, 16, v32
    v_lshlrev_b32 v33, 16, v33
    v_lshlrev_b32 v34, 16, v34
    v_lshlrev_b32 v35, 16, v35
    v_mul_f32 v36, 0xbfb8aa3b, v32
    v_mul_f32 v37, 0xbfb8aa3b, v33
    v_mul_f32 v38, 0xbfb8aa3b, v34
    v_mul_f32 v39, 0xbfb8aa3b, v35
    v_exp_f32 v36, v36
    v_exp_f32 v37, v37
    v_exp_f32 v38, v38
    v_exp_f32 v39, v39
    v_add_f32 v36, 1.0, v36
    v_add_f32 v37, 1.0, v37
    v_add_f32 v38, 1.0, v38
    v_add_f32 v39, 1.0, v39
    v_rcp_f32 v36, v36
    v_rcp_f32 v37, v37
    v_rcp_f32 v38, v38
    v_rcp_f32 v39, v39
    v_mul_f32 v32, v32, v36
    v_mul_f32 v33, v33, v37
    v_mul_f32 v34, v34, v38
    v_mul_f32 v35, v35, v39
    v_cvt_pk_bf16_f32 v32, v32, v32
    v_cvt_pk_bf16_f32 v33, v33, v33
    v_cvt_pk_bf16_f32 v34, v34, v34
    v_cvt_pk_bf16_f32 v35, v35, v35
    v_lshlrev_b32 v32, 16, v32
    v_lshlrev_b32 v33, 16, v33
    v_lshlrev_b32 v34, 16, v34
    v_lshlrev_b32 v35, 16, v35
    v_cvt_pk_bf16_f32 v40, v64, v64
    v_cvt_pk_bf16_f32 v41, v65, v65
    v_cvt_pk_bf16_f32 v42, v66, v66
    v_cvt_pk_bf16_f32 v43, v67, v67
    v_lshlrev_b32 v40, 16, v40
    v_lshlrev_b32 v41, 16, v41
    v_lshlrev_b32 v42, 16, v42
    v_lshlrev_b32 v43, 16, v43
    v_mul_f32 v32, v32, v40
    v_mul_f32 v33, v33, v41
    v_mul_f32 v34, v34, v42
    v_mul_f32 v35, v35, v43
    v_cvt_pk_bf16_f32 v32, v32, v32
    v_cvt_pk_bf16_f32 v33, v33, v33
    v_cvt_pk_bf16_f32 v34, v34, v34
    v_cvt_pk_bf16_f32 v35, v35, v35
    v_lshlrev_b32 v32, 16, v32
    v_lshlrev_b32 v33, 16, v33
    v_lshlrev_b32 v34, 16, v34
    v_lshlrev_b32 v35, 16, v35
    v_lshlrev_b32 v40, 16, v8
    v_and_b32 v41, 0xffff0000, v8
    v_lshlrev_b32 v42, 16, v9
    v_and_b32 v43, 0xffff0000, v9
    v_add_f32 v28, v32, v40
    v_add_f32 v29, v33, v41
    v_add_f32 v30, v34, v42
    v_add_f32 v31, v35, v43
    v_cvt_pk_bf16_f32 v26, v28, v29
    v_cvt_pk_bf16_f32 v27, v30, v31
    global_store_dwordx2 v6, v[26:27], s[12:13] offset:0
    s_nop 1
    s_waitcnt vmcnt(6)
    v_cvt_pk_bf16_f32 v32, v112, v112
    v_cvt_pk_bf16_f32 v33, v113, v113
    v_cvt_pk_bf16_f32 v34, v114, v114
    v_cvt_pk_bf16_f32 v35, v115, v115
    v_lshlrev_b32 v32, 16, v32
    v_lshlrev_b32 v33, 16, v33
    v_lshlrev_b32 v34, 16, v34
    v_lshlrev_b32 v35, 16, v35
    v_mul_f32 v36, 0xbfb8aa3b, v32
    v_mul_f32 v37, 0xbfb8aa3b, v33
    v_mul_f32 v38, 0xbfb8aa3b, v34
    v_mul_f32 v39, 0xbfb8aa3b, v35
    v_exp_f32 v36, v36
    v_exp_f32 v37, v37
    v_exp_f32 v38, v38
    v_exp_f32 v39, v39
    v_add_f32 v36, 1.0, v36
    v_add_f32 v37, 1.0, v37
    v_add_f32 v38, 1.0, v38
    v_add_f32 v39, 1.0, v39
    v_rcp_f32 v36, v36
    v_rcp_f32 v37, v37
    v_rcp_f32 v38, v38
    v_rcp_f32 v39, v39
    v_mul_f32 v32, v32, v36
    v_mul_f32 v33, v33, v37
    v_mul_f32 v34, v34, v38
    v_mul_f32 v35, v35, v39
    v_cvt_pk_bf16_f32 v32, v32, v32
    v_cvt_pk_bf16_f32 v33, v33, v33
    v_cvt_pk_bf16_f32 v34, v34, v34
    v_cvt_pk_bf16_f32 v35, v35, v35
    v_lshlrev_b32 v32, 16, v32
    v_lshlrev_b32 v33, 16, v33
    v_lshlrev_b32 v34, 16, v34
    v_lshlrev_b32 v35, 16, v35
    v_cvt_pk_bf16_f32 v40, v80, v80
    v_cvt_pk_bf16_f32 v41, v81, v81
    v_cvt_pk_bf16_f32 v42, v82, v82
    v_cvt_pk_bf16_f32 v43, v83, v83
    v_lshlrev_b32 v40, 16, v40
    v_lshlrev_b32 v41, 16, v41
    v_lshlrev_b32 v42, 16, v42
    v_lshlrev_b32 v43, 16, v43
    v_mul_f32 v32, v32, v40
    v_mul_f32 v33, v33, v41
    v_mul_f32 v34, v34, v42
    v_mul_f32 v35, v35, v43
    v_cvt_pk_bf16_f32 v32, v32, v32
    v_cvt_pk_bf16_f32 v33, v33, v33
    v_cvt_pk_bf16_f32 v34, v34, v34
    v_cvt_pk_bf16_f32 v35, v35, v35
    v_lshlrev_b32 v32, 16, v32
    v_lshlrev_b32 v33, 16, v33
    v_lshlrev_b32 v34, 16, v34
    v_lshlrev_b32 v35, 16, v35
    v_lshlrev_b32 v40, 16, v16
    v_and_b32 v41, 0xffff0000, v16
    v_lshlrev_b32 v42, 16, v17
    v_and_b32 v43, 0xffff0000, v17
    v_add_f32 v28, v32, v40
    v_add_f32 v29, v33, v41
    v_add_f32 v30, v34, v42
    v_add_f32 v31, v35, v43
    v_cvt_pk_bf16_f32 v26, v28, v29
    v_cvt_pk_bf16_f32 v27, v30, v31
    global_store_dwordx2 v6, v[26:27], s[12:13] offset:32
    s_nop 1
    v_add_u32 v6, 32768, v5
    s_waitcnt vmcnt(5)
    v_cvt_pk_bf16_f32 v32, v100, v100
    v_cvt_pk_bf16_f32 v33, v101, v101
    v_cvt_pk_bf16_f32 v34, v102, v102
    v_cvt_pk_bf16_f32 v35, v103, v103
    v_lshlrev_b32 v32, 16, v32
    v_lshlrev_b32 v33, 16, v33
    v_lshlrev_b32 v34, 16, v34
    v_lshlrev_b32 v35, 16, v35
    v_mul_f32 v36, 0xbfb8aa3b, v32
    v_mul_f32 v37, 0xbfb8aa3b, v33
    v_mul_f32 v38, 0xbfb8aa3b, v34
    v_mul_f32 v39, 0xbfb8aa3b, v35
    v_exp_f32 v36, v36
    v_exp_f32 v37, v37
    v_exp_f32 v38, v38
    v_exp_f32 v39, v39
    v_add_f32 v36, 1.0, v36
    v_add_f32 v37, 1.0, v37
    v_add_f32 v38, 1.0, v38
    v_add_f32 v39, 1.0, v39
    v_rcp_f32 v36, v36
    v_rcp_f32 v37, v37
    v_rcp_f32 v38, v38
    v_rcp_f32 v39, v39
    v_mul_f32 v32, v32, v36
    v_mul_f32 v33, v33, v37
    v_mul_f32 v34, v34, v38
    v_mul_f32 v35, v35, v39
    v_cvt_pk_bf16_f32 v32, v32, v32
    v_cvt_pk_bf16_f32 v33, v33, v33
    v_cvt_pk_bf16_f32 v34, v34, v34
    v_cvt_pk_bf16_f32 v35, v35, v35
    v_lshlrev_b32 v32, 16, v32
    v_lshlrev_b32 v33, 16, v33
    v_lshlrev_b32 v34, 16, v34
    v_lshlrev_b32 v35, 16, v35
    v_cvt_pk_bf16_f32 v40, v68, v68
    v_cvt_pk_bf16_f32 v41, v69, v69
    v_cvt_pk_bf16_f32 v42, v70, v70
    v_cvt_pk_bf16_f32 v43, v71, v71
    v_lshlrev_b32 v40, 16, v40
    v_lshlrev_b32 v41, 16, v41
    v_lshlrev_b32 v42, 16, v42
    v_lshlrev_b32 v43, 16, v43
    v_mul_f32 v32, v32, v40
    v_mul_f32 v33, v33, v41
    v_mul_f32 v34, v34, v42
    v_mul_f32 v35, v35, v43
    v_cvt_pk_bf16_f32 v32, v32, v32
    v_cvt_pk_bf16_f32 v33, v33, v33
    v_cvt_pk_bf16_f32 v34, v34, v34
    v_cvt_pk_bf16_f32 v35, v35, v35
    v_lshlrev_b32 v32, 16, v32
    v_lshlrev_b32 v33, 16, v33
    v_lshlrev_b32 v34, 16, v34
    v_lshlrev_b32 v35, 16, v35
    v_lshlrev_b32 v40, 16, v10
    v_and_b32 v41, 0xffff0000, v10
    v_lshlrev_b32 v42, 16, v11
    v_and_b32 v43, 0xffff0000, v11
    v_add_f32 v28, v32, v40
    v_add_f32 v29, v33, v41
    v_add_f32 v30, v34, v42
    v_add_f32 v31, v35, v43
    v_cvt_pk_bf16_f32 v26, v28, v29
    v_cvt_pk_bf16_f32 v27, v30, v31
    global_store_dwordx2 v6, v[26:27], s[12:13] offset:0
    s_nop 1
    s_waitcnt vmcnt(4)
    v_cvt_pk_bf16_f32 v32, v116, v116
    v_cvt_pk_bf16_f32 v33, v117, v117
    v_cvt_pk_bf16_f32 v34, v118, v118
    v_cvt_pk_bf16_f32 v35, v119, v119
    v_lshlrev_b32 v32, 16, v32
    v_lshlrev_b32 v33, 16, v33
    v_lshlrev_b32 v34, 16, v34
    v_lshlrev_b32 v35, 16, v35
    v_mul_f32 v36, 0xbfb8aa3b, v32
    v_mul_f32 v37, 0xbfb8aa3b, v33
    v_mul_f32 v38, 0xbfb8aa3b, v34
    v_mul_f32 v39, 0xbfb8aa3b, v35
    v_exp_f32 v36, v36
    v_exp_f32 v37, v37
    v_exp_f32 v38, v38
    v_exp_f32 v39, v39
    v_add_f32 v36, 1.0, v36
    v_add_f32 v37, 1.0, v37
    v_add_f32 v38, 1.0, v38
    v_add_f32 v39, 1.0, v39
    v_rcp_f32 v36, v36
    v_rcp_f32 v37, v37
    v_rcp_f32 v38, v38
    v_rcp_f32 v39, v39
    v_mul_f32 v32, v32, v36
    v_mul_f32 v33, v33, v37
    v_mul_f32 v34, v34, v38
    v_mul_f32 v35, v35, v39
    v_cvt_pk_bf16_f32 v32, v32, v32
    v_cvt_pk_bf16_f32 v33, v33, v33
    v_cvt_pk_bf16_f32 v34, v34, v34
    v_cvt_pk_bf16_f32 v35, v35, v35
    v_lshlrev_b32 v32, 16, v32
    v_lshlrev_b32 v33, 16, v33
    v_lshlrev_b32 v34, 16, v34
    v_lshlrev_b32 v35, 16, v35
    v_cvt_pk_bf16_f32 v40, v84, v84
    v_cvt_pk_bf16_f32 v41, v85, v85
    v_cvt_pk_bf16_f32 v42, v86, v86
    v_cvt_pk_bf16_f32 v43, v87, v87
    v_lshlrev_b32 v40, 16, v40
    v_lshlrev_b32 v41, 16, v41
    v_lshlrev_b32 v42, 16, v42
    v_lshlrev_b32 v43, 16, v43
    v_mul_f32 v32, v32, v40
    v_mul_f32 v33, v33, v41
    v_mul_f32 v34, v34, v42
    v_mul_f32 v35, v35, v43
    v_cvt_pk_bf16_f32 v32, v32, v32
    v_cvt_pk_bf16_f32 v33, v33, v33
    v_cvt_pk_bf16_f32 v34, v34, v34
    v_cvt_pk_bf16_f32 v35, v35, v35
    v_lshlrev_b32 v32, 16, v32
    v_lshlrev_b32 v33, 16, v33
    v_lshlrev_b32 v34, 16, v34
    v_lshlrev_b32 v35, 16, v35
    v_lshlrev_b32 v40, 16, v18
    v_and_b32 v41, 0xffff0000, v18
    v_lshlrev_b32 v42, 16, v19
    v_and_b32 v43, 0xffff0000, v19
    v_add_f32 v28, v32, v40
    v_add_f32 v29, v33, v41
    v_add_f32 v30, v34, v42
    v_add_f32 v31, v35, v43
    v_cvt_pk_bf16_f32 v26, v28, v29
    v_cvt_pk_bf16_f32 v27, v30, v31
    global_store_dwordx2 v6, v[26:27], s[12:13] offset:32
    s_nop 1
    v_add_u32 v6, 65536, v5
    s_waitcnt vmcnt(3)
    v_cvt_pk_bf16_f32 v32, v104, v104
    v_cvt_pk_bf16_f32 v33, v105, v105
    v_cvt_pk_bf16_f32 v34, v106, v106
    v_cvt_pk_bf16_f32 v35, v107, v107
    v_lshlrev_b32 v32, 16, v32
    v_lshlrev_b32 v33, 16, v33
    v_lshlrev_b32 v34, 16, v34
    v_lshlrev_b32 v35, 16, v35
    v_mul_f32 v36, 0xbfb8aa3b, v32
    v_mul_f32 v37, 0xbfb8aa3b, v33
    v_mul_f32 v38, 0xbfb8aa3b, v34
    v_mul_f32 v39, 0xbfb8aa3b, v35
    v_exp_f32 v36, v36
    v_exp_f32 v37, v37
    v_exp_f32 v38, v38
    v_exp_f32 v39, v39
    v_add_f32 v36, 1.0, v36
    v_add_f32 v37, 1.0, v37
    v_add_f32 v38, 1.0, v38
    v_add_f32 v39, 1.0, v39
    v_rcp_f32 v36, v36
    v_rcp_f32 v37, v37
    v_rcp_f32 v38, v38
    v_rcp_f32 v39, v39
    v_mul_f32 v32, v32, v36
    v_mul_f32 v33, v33, v37
    v_mul_f32 v34, v34, v38
    v_mul_f32 v35, v35, v39
    v_cvt_pk_bf16_f32 v32, v32, v32
    v_cvt_pk_bf16_f32 v33, v33, v33
    v_cvt_pk_bf16_f32 v34, v34, v34
    v_cvt_pk_bf16_f32 v35, v35, v35
    v_lshlrev_b32 v32, 16, v32
    v_lshlrev_b32 v33, 16, v33
    v_lshlrev_b32 v34, 16, v34
    v_lshlrev_b32 v35, 16, v35
    v_cvt_pk_bf16_f32 v40, v72, v72
    v_cvt_pk_bf16_f32 v41, v73, v73
    v_cvt_pk_bf16_f32 v42, v74, v74
    v_cvt_pk_bf16_f32 v43, v75, v75
    v_lshlrev_b32 v40, 16, v40
    v_lshlrev_b32 v41, 16, v41
    v_lshlrev_b32 v42, 16, v42
    v_lshlrev_b32 v43, 16, v43
    v_mul_f32 v32, v32, v40
    v_mul_f32 v33, v33, v41
    v_mul_f32 v34, v34, v42
    v_mul_f32 v35, v35, v43
    v_cvt_pk_bf16_f32 v32, v32, v32
    v_cvt_pk_bf16_f32 v33, v33, v33
    v_cvt_pk_bf16_f32 v34, v34, v34
    v_cvt_pk_bf16_f32 v35, v35, v35
    v_lshlrev_b32 v32, 16, v32
    v_lshlrev_b32 v33, 16, v33
    v_lshlrev_b32 v34, 16, v34
    v_lshlrev_b32 v35, 16, v35
    v_lshlrev_b32 v40, 16, v12
    v_and_b32 v41, 0xffff0000, v12
    v_lshlrev_b32 v42, 16, v13
    v_and_b32 v43, 0xffff0000, v13
    v_add_f32 v28, v32, v40
    v_add_f32 v29, v33, v41
    v_add_f32 v30, v34, v42
    v_add_f32 v31, v35, v43
    v_cvt_pk_bf16_f32 v26, v28, v29
    v_cvt_pk_bf16_f32 v27, v30, v31
    global_store_dwordx2 v6, v[26:27], s[12:13] offset:0
    s_nop 1
    s_waitcnt vmcnt(2)
    v_cvt_pk_bf16_f32 v32, v120, v120
    v_cvt_pk_bf16_f32 v33, v121, v121
    v_cvt_pk_bf16_f32 v34, v122, v122
    v_cvt_pk_bf16_f32 v35, v123, v123
    v_lshlrev_b32 v32, 16, v32
    v_lshlrev_b32 v33, 16, v33
    v_lshlrev_b32 v34, 16, v34
    v_lshlrev_b32 v35, 16, v35
    v_mul_f32 v36, 0xbfb8aa3b, v32
    v_mul_f32 v37, 0xbfb8aa3b, v33
    v_mul_f32 v38, 0xbfb8aa3b, v34
    v_mul_f32 v39, 0xbfb8aa3b, v35
    v_exp_f32 v36, v36
    v_exp_f32 v37, v37
    v_exp_f32 v38, v38
    v_exp_f32 v39, v39
    v_add_f32 v36, 1.0, v36
    v_add_f32 v37, 1.0, v37
    v_add_f32 v38, 1.0, v38
    v_add_f32 v39, 1.0, v39
    v_rcp_f32 v36, v36
    v_rcp_f32 v37, v37
    v_rcp_f32 v38, v38
    v_rcp_f32 v39, v39
    v_mul_f32 v32, v32, v36
    v_mul_f32 v33, v33, v37
    v_mul_f32 v34, v34, v38
    v_mul_f32 v35, v35, v39
    v_cvt_pk_bf16_f32 v32, v32, v32
    v_cvt_pk_bf16_f32 v33, v33, v33
    v_cvt_pk_bf16_f32 v34, v34, v34
    v_cvt_pk_bf16_f32 v35, v35, v35
    v_lshlrev_b32 v32, 16, v32
    v_lshlrev_b32 v33, 16, v33
    v_lshlrev_b32 v34, 16, v34
    v_lshlrev_b32 v35, 16, v35
    v_cvt_pk_bf16_f32 v40, v88, v88
    v_cvt_pk_bf16_f32 v41, v89, v89
    v_cvt_pk_bf16_f32 v42, v90, v90
    v_cvt_pk_bf16_f32 v43, v91, v91
    v_lshlrev_b32 v40, 16, v40
    v_lshlrev_b32 v41, 16, v41
    v_lshlrev_b32 v42, 16, v42
    v_lshlrev_b32 v43, 16, v43
    v_mul_f32 v32, v32, v40
    v_mul_f32 v33, v33, v41
    v_mul_f32 v34, v34, v42
    v_mul_f32 v35, v35, v43
    v_cvt_pk_bf16_f32 v32, v32, v32
    v_cvt_pk_bf16_f32 v33, v33, v33
    v_cvt_pk_bf16_f32 v34, v34, v34
    v_cvt_pk_bf16_f32 v35, v35, v35
    v_lshlrev_b32 v32, 16, v32
    v_lshlrev_b32 v33, 16, v33
    v_lshlrev_b32 v34, 16, v34
    v_lshlrev_b32 v35, 16, v35
    v_lshlrev_b32 v40, 16, v20
    v_and_b32 v41, 0xffff0000, v20
    v_lshlrev_b32 v42, 16, v21
    v_and_b32 v43, 0xffff0000, v21
    v_add_f32 v28, v32, v40
    v_add_f32 v29, v33, v41
    v_add_f32 v30, v34, v42
    v_add_f32 v31, v35, v43
    v_cvt_pk_bf16_f32 v26, v28, v29
    v_cvt_pk_bf16_f32 v27, v30, v31
    global_store_dwordx2 v6, v[26:27], s[12:13] offset:32
    s_nop 1
    v_add_u32 v6, 98304, v5
    s_waitcnt vmcnt(1)
    v_cvt_pk_bf16_f32 v32, v108, v108
    v_cvt_pk_bf16_f32 v33, v109, v109
    v_cvt_pk_bf16_f32 v34, v110, v110
    v_cvt_pk_bf16_f32 v35, v111, v111
    v_lshlrev_b32 v32, 16, v32
    v_lshlrev_b32 v33, 16, v33
    v_lshlrev_b32 v34, 16, v34
    v_lshlrev_b32 v35, 16, v35
    v_mul_f32 v36, 0xbfb8aa3b, v32
    v_mul_f32 v37, 0xbfb8aa3b, v33
    v_mul_f32 v38, 0xbfb8aa3b, v34
    v_mul_f32 v39, 0xbfb8aa3b, v35
    v_exp_f32 v36, v36
    v_exp_f32 v37, v37
    v_exp_f32 v38, v38
    v_exp_f32 v39, v39
    v_add_f32 v36, 1.0, v36
    v_add_f32 v37, 1.0, v37
    v_add_f32 v38, 1.0, v38
    v_add_f32 v39, 1.0, v39
    v_rcp_f32 v36, v36
    v_rcp_f32 v37, v37
    v_rcp_f32 v38, v38
    v_rcp_f32 v39, v39
    v_mul_f32 v32, v32, v36
    v_mul_f32 v33, v33, v37
    v_mul_f32 v34, v34, v38
    v_mul_f32 v35, v35, v39
    v_cvt_pk_bf16_f32 v32, v32, v32
    v_cvt_pk_bf16_f32 v33, v33, v33
    v_cvt_pk_bf16_f32 v34, v34, v34
    v_cvt_pk_bf16_f32 v35, v35, v35
    v_lshlrev_b32 v32, 16, v32
    v_lshlrev_b32 v33, 16, v33
    v_lshlrev_b32 v34, 16, v34
    v_lshlrev_b32 v35, 16, v35
    v_cvt_pk_bf16_f32 v40, v76, v76
    v_cvt_pk_bf16_f32 v41, v77, v77
    v_cvt_pk_bf16_f32 v42, v78, v78
    v_cvt_pk_bf16_f32 v43, v79, v79
    v_lshlrev_b32 v40, 16, v40
    v_lshlrev_b32 v41, 16, v41
    v_lshlrev_b32 v42, 16, v42
    v_lshlrev_b32 v43, 16, v43
    v_mul_f32 v32, v32, v40
    v_mul_f32 v33, v33, v41
    v_mul_f32 v34, v34, v42
    v_mul_f32 v35, v35, v43
    v_cvt_pk_bf16_f32 v32, v32, v32
    v_cvt_pk_bf16_f32 v33, v33, v33
    v_cvt_pk_bf16_f32 v34, v34, v34
    v_cvt_pk_bf16_f32 v35, v35, v35
    v_lshlrev_b32 v32, 16, v32
    v_lshlrev_b32 v33, 16, v33
    v_lshlrev_b32 v34, 16, v34
    v_lshlrev_b32 v35, 16, v35
    v_lshlrev_b32 v40, 16, v14
    v_and_b32 v41, 0xffff0000, v14
    v_lshlrev_b32 v42, 16, v15
    v_and_b32 v43, 0xffff0000, v15
    v_add_f32 v28, v32, v40
    v_add_f32 v29, v33, v41
    v_add_f32 v30, v34, v42
    v_add_f32 v31, v35, v43
    v_cvt_pk_bf16_f32 v26, v28, v29
    v_cvt_pk_bf16_f32 v27, v30, v31
    global_store_dwordx2 v6, v[26:27], s[12:13] offset:0
    s_nop 1
    s_waitcnt vmcnt(0)
    v_cvt_pk_bf16_f32 v32, v124, v124
    v_cvt_pk_bf16_f32 v33, v125, v125
    v_cvt_pk_bf16_f32 v34, v126, v126
    v_cvt_pk_bf16_f32 v35, v127, v127
    v_lshlrev_b32 v32, 16, v32
    v_lshlrev_b32 v33, 16, v33
    v_lshlrev_b32 v34, 16, v34
    v_lshlrev_b32 v35, 16, v35
    v_mul_f32 v36, 0xbfb8aa3b, v32
    v_mul_f32 v37, 0xbfb8aa3b, v33
    v_mul_f32 v38, 0xbfb8aa3b, v34
    v_mul_f32 v39, 0xbfb8aa3b, v35
    v_exp_f32 v36, v36
    v_exp_f32 v37, v37
    v_exp_f32 v38, v38
    v_exp_f32 v39, v39
    v_add_f32 v36, 1.0, v36
    v_add_f32 v37, 1.0, v37
    v_add_f32 v38, 1.0, v38
    v_add_f32 v39, 1.0, v39
    v_rcp_f32 v36, v36
    v_rcp_f32 v37, v37
    v_rcp_f32 v38, v38
    v_rcp_f32 v39, v39
    v_mul_f32 v32, v32, v36
    v_mul_f32 v33, v33, v37
    v_mul_f32 v34, v34, v38
    v_mul_f32 v35, v35, v39
    v_cvt_pk_bf16_f32 v32, v32, v32
    v_cvt_pk_bf16_f32 v33, v33, v33
    v_cvt_pk_bf16_f32 v34, v34, v34
    v_cvt_pk_bf16_f32 v35, v35, v35
    v_lshlrev_b32 v32, 16, v32
    v_lshlrev_b32 v33, 16, v33
    v_lshlrev_b32 v34, 16, v34
    v_lshlrev_b32 v35, 16, v35
    v_cvt_pk_bf16_f32 v40, v92, v92
    v_cvt_pk_bf16_f32 v41, v93, v93
    v_cvt_pk_bf16_f32 v42, v94, v94
    v_cvt_pk_bf16_f32 v43, v95, v95
    v_lshlrev_b32 v40, 16, v40
    v_lshlrev_b32 v41, 16, v41
    v_lshlrev_b32 v42, 16, v42
    v_lshlrev_b32 v43, 16, v43
    v_mul_f32 v32, v32, v40
    v_mul_f32 v33, v33, v41
    v_mul_f32 v34, v34, v42
    v_mul_f32 v35, v35, v43
    v_cvt_pk_bf16_f32 v32, v32, v32
    v_cvt_pk_bf16_f32 v33, v33, v33
    v_cvt_pk_bf16_f32 v34, v34, v34
    v_cvt_pk_bf16_f32 v35, v35, v35
    v_lshlrev_b32 v32, 16, v32
    v_lshlrev_b32 v33, 16, v33
    v_lshlrev_b32 v34, 16, v34
    v_lshlrev_b32 v35, 16, v35
    v_lshlrev_b32 v40, 16, v22
    v_and_b32 v41, 0xffff0000, v22
    v_lshlrev_b32 v42, 16, v23
    v_and_b32 v43, 0xffff0000, v23
    v_add_f32 v28, v32, v40
    v_add_f32 v29, v33, v41
    v_add_f32 v30, v34, v42
    v_add_f32 v31, v35, v43
    v_cvt_pk_bf16_f32 v26, v28, v29
    v_cvt_pk_bf16_f32 v27, v30, v31
    global_store_dwordx2 v6, v[26:27], s[12:13] offset:32
    s_nop 1
    s_endpgm
L_g2_loader_16:
    s_sub_u32 s20, s20, 4
    v_lshrrev_b32 v3, 4, v2
    v_and_b32 v4, 15, v2
    v_lshrrev_b32 v7, 3, v2
    v_and_b32 v8, 7, v2
    v_and_b32 v9, 1, v3
    v_or_b32 v9, 0, v9
    v_lshrrev_b32 v10, 1, v8
    v_xor_b32 v10, v10, v9
    v_and_b32 v11, 1, v8
    v_lshl_or_b32 v10, v10, 1, v11
    v_lshlrev_b32 v10, 4, v10
    v_lshl_add_u32 v56, v7, 11, v10
    v_and_b32 v9, 1, v3
    v_or_b32 v9, 2, v9
    v_lshrrev_b32 v10, 1, v8
    v_xor_b32 v10, v10, v9
    v_and_b32 v11, 1, v8
    v_lshl_or_b32 v10, v10, 1, v11
    v_lshlrev_b32 v10, 4, v10
    v_lshl_add_u32 v57, v7, 11, v10
    s_waitcnt lgkmcnt(0)
    s_lshl_b32 s25, s20, 13
    s_lshl_b32 s26, s20, 12
    s_mov_b32 s32, 2048
    v_or_b32 v9, 0, v3
    v_xor_b32 v9, v4, v9
    v_lshlrev_b32 v9, 4, v9
    v_mul_u32_u24 v10, 2048, v3
    v_add_u32 v52, v9, v10
    v_or_b32 v9, 4, v3
    v_xor_b32 v9, v4, v9
    v_lshlrev_b32 v9, 4, v9
    v_mul_u32_u24 v10, 2048, v3
    v_add_u32 v53, v9, v10
    v_or_b32 v9, 8, v3
    v_xor_b32 v9, v4, v9
    v_lshlrev_b32 v9, 4, v9
    v_mul_u32_u24 v10, 2048, v3
    v_add_u32 v54, v9, v10
    v_or_b32 v9, 12, v3
    v_xor_b32 v9, v4, v9
    v_lshlrev_b32 v9, 4, v9
    v_mul_u32_u24 v10, 2048, v3
    v_add_u32 v55, v9, v10
    s_lshl_b32 s28, s23, 7
    s_lshl_b32 s29, s20, 5
    s_add_u32 s28, s28, s29
    s_mul_i32 s28, s28, 2048
    s_add_u32 s28, s28, 31457280
    s_add_u32 s16, s10, s28
    s_addc_u32 s17, s11, 0
    s_lshl_b32 s28, s20, 16
    s_lshl_b32 s29, s24, 7
    s_add_u32 s28, s28, s29
    s_add_u32 s18, s4, s28
    s_addc_u32 s19, s5, 0
    s_mul_i32 s28, s32, 0
    s_add_u32 s36, s16, s28
    s_addc_u32 s37, s17, 0
    s_add_u32 m0, s25, 0
    s_nop 0
    global_load_lds_dwordx4 v52, s[36:37]
    s_mul_i32 s28, s32, 4
    s_add_u32 s36, s16, s28
    s_addc_u32 s37, s17, 0
    s_add_u32 m0, s25, 1024
    s_nop 0
    global_load_lds_dwordx4 v53, s[36:37]
    s_mul_i32 s28, s32, 8
    s_add_u32 s36, s16, s28
    s_addc_u32 s37, s17, 0
    s_add_u32 m0, s25, 2048
    s_nop 0
    global_load_lds_dwordx4 v54, s[36:37]
    s_mul_i32 s28, s32, 12
    s_add_u32 s36, s16, s28
    s_addc_u32 s37, s17, 0
    s_add_u32 m0, s25, 3072
    s_nop 0
    global_load_lds_dwordx4 v55, s[36:37]
    s_mul_i32 s28, s32, 16
    s_add_u32 s36, s16, s28
    s_addc_u32 s37, s17, 0
    s_add_u32 m0, s25, 4096
    s_nop 0
    global_load_lds_dwordx4 v52, s[36:37]
    s_mul_i32 s28, s32, 20
    s_add_u32 s36, s16, s28
    s_addc_u32 s37, s17, 0
    s_add_u32 m0, s25, 5120
    s_nop 0
    global_load_lds_dwordx4 v53, s[36:37]
    s_mul_i32 s28, s32, 24
    s_add_u32 s36, s16, s28
    s_addc_u32 s37, s17, 0
    s_add_u32 m0, s25, 6144
    s_nop 0
    global_load_lds_dwordx4 v54, s[36:37]
    s_mul_i32 s28, s32, 28
    s_add_u32 s36, s16, s28
    s_addc_u32 s37, s17, 0
    s_add_u32 m0, s25, 7168
    s_nop 0
    global_load_lds_dwordx4 v55, s[36:37]
    s_add_u32 s36, s18, 0
    s_addc_u32 s37, s19, 0
    s_add_u32 m0, s26, 32768
    s_nop 0
    global_load_lds_dwordx4 v56, s[36:37]
    s_add_u32 s36, s18, 16384
    s_addc_u32 s37, s19, 0
    s_add_u32 m0, s26, 33792
    s_nop 0
    global_load_lds_dwordx4 v57, s[36:37]
    s_add_u32 s36, s18, 32768
    s_addc_u32 s37, s19, 0
    s_add_u32 m0, s26, 34816
    s_nop 0
    global_load_lds_dwordx4 v56, s[36:37]
    s_add_u32 s36, s18, 49152
    s_addc_u32 s37, s19, 0
    s_add_u32 m0, s26, 35840
    s_nop 0
    global_load_lds_dwordx4 v57, s[36:37]
    s_add_u32 s16, s16, 256
    s_addc_u32 s17, s17, 0
    s_add_u32 s18, s18, 262144
    s_addc_u32 s19, s19, 0
    s_mul_i32 s28, s32, 0
    s_add_u32 s36, s16, s28
    s_addc_u32 s37, s17, 0
    s_add_u32 m0, s25, 49152
    s_nop 0
    global_load_lds_dwordx4 v52, s[36:37]
    s_mul_i32 s28, s32, 4
    s_add_u32 s36, s16, s28
    s_addc_u32 s37, s17, 0
    s_add_u32 m0, s25, 50176
    s_nop 0
    global_load_lds_dwordx4 v53, s[36:37]
    s_mul_i32 s28, s32, 8
    s_add_u32 s36, s16, s28
    s_addc_u32 s37, s17, 0
    s_add_u32 m0, s25, 51200
    s_nop 0
    global_load_lds_dwordx4 v54, s[36:37]
    s_mul_i32 s28, s32, 12
    s_add_u32 s36, s16, s28
    s_addc_u32 s37, s17, 0
    s_add_u32 m0, s25, 52224
    s_nop 0
    global_load_lds_dwordx4 v55, s[36:37]
    s_mul_i32 s28, s32, 16
    s_add_u32 s36, s16, s28
    s_addc_u32 s37, s17, 0
    s_add_u32 m0, s25, 53248
    s_nop 0
    global_load_lds_dwordx4 v52, s[36:37]
    s_mul_i32 s28, s32, 20
    s_add_u32 s36, s16, s28
    s_addc_u32 s37, s17, 0
    s_add_u32 m0, s25, 54272
    s_nop 0
    global_load_lds_dwordx4 v53, s[36:37]
    s_mul_i32 s28, s32, 24
    s_add_u32 s36, s16, s28
    s_addc_u32 s37, s17, 0
    s_add_u32 m0, s25, 55296
    s_nop 0
    global_load_lds_dwordx4 v54, s[36:37]
    s_mul_i32 s28, s32, 28
    s_add_u32 s36, s16, s28
    s_addc_u32 s37, s17, 0
    s_add_u32 m0, s25, 56320
    s_nop 0
    global_load_lds_dwordx4 v55, s[36:37]
    s_add_u32 s36, s18, 0
    s_addc_u32 s37, s19, 0
    s_add_u32 m0, s26, 81920
    s_nop 0
    global_load_lds_dwordx4 v56, s[36:37]
    s_add_u32 s36, s18, 16384
    s_addc_u32 s37, s19, 0
    s_add_u32 m0, s26, 82944
    s_nop 0
    global_load_lds_dwordx4 v57, s[36:37]
    s_add_u32 s36, s18, 32768
    s_addc_u32 s37, s19, 0
    s_add_u32 m0, s26, 83968
    s_nop 0
    global_load_lds_dwordx4 v56, s[36:37]
    s_add_u32 s36, s18, 49152
    s_addc_u32 s37, s19, 0
    s_add_u32 m0, s26, 84992
    s_nop 0
    global_load_lds_dwordx4 v57, s[36:37]
    s_add_u32 s16, s16, 256
    s_addc_u32 s17, s17, 0
    s_add_u32 s18, s18, 262144
    s_addc_u32 s19, s19, 0
    s_waitcnt vmcnt(12)
    s_mov_b32 s27, 2
L_g2_la_19:
    s_barrier
    s_mul_i32 s28, s32, 0
    s_add_u32 s36, s16, s28
    s_addc_u32 s37, s17, 0
    s_add_u32 m0, s25, 98304
    s_nop 0
    global_load_lds_dwordx4 v52, s[36:37]
    s_mul_i32 s28, s32, 4
    s_add_u32 s36, s16, s28
    s_addc_u32 s37, s17, 0
    s_add_u32 m0, s25, 99328
    s_nop 0
    global_load_lds_dwordx4 v53, s[36:37]
    s_mul_i32 s28, s32, 8
    s_add_u32 s36, s16, s28
    s_addc_u32 s37, s17, 0
    s_add_u32 m0, s25, 100352
    s_nop 0
    global_load_lds_dwordx4 v54, s[36:37]
    s_mul_i32 s28, s32, 12
    s_add_u32 s36, s16, s28
    s_addc_u32 s37, s17, 0
    s_add_u32 m0, s25, 101376
    s_nop 0
    global_load_lds_dwordx4 v55, s[36:37]
    s_mul_i32 s28, s32, 16
    s_add_u32 s36, s16, s28
    s_addc_u32 s37, s17, 0
    s_add_u32 m0, s25, 102400
    s_nop 0
    global_load_lds_dwordx4 v52, s[36:37]
    s_mul_i32 s28, s32, 20
    s_add_u32 s36, s16, s28
    s_addc_u32 s37, s17, 0
    s_add_u32 m0, s25, 103424
    s_nop 0
    global_load_lds_dwordx4 v53, s[36:37]
    s_mul_i32 s28, s32, 24
    s_add_u32 s36, s16, s28
    s_addc_u32 s37, s17, 0
    s_add_u32 m0, s25, 104448
    s_nop 0
    global_load_lds_dwordx4 v54, s[36:37]
    s_mul_i32 s28, s32, 28
    s_add_u32 s36, s16, s28
    s_addc_u32 s37, s17, 0
    s_add_u32 m0, s25, 105472
    s_nop 0
    global_load_lds_dwordx4 v55, s[36:37]
    s_add_u32 s36, s18, 0
    s_addc_u32 s37, s19, 0
    s_add_u32 m0, s26, 131072
    s_nop 0
    global_load_lds_dwordx4 v56, s[36:37]
    s_add_u32 s36, s18, 16384
    s_addc_u32 s37, s19, 0
    s_add_u32 m0, s26, 132096
    s_nop 0
    global_load_lds_dwordx4 v57, s[36:37]
    s_add_u32 s36, s18, 32768
    s_addc_u32 s37, s19, 0
    s_add_u32 m0, s26, 133120
    s_nop 0
    global_load_lds_dwordx4 v56, s[36:37]
    s_add_u32 s36, s18, 49152
    s_addc_u32 s37, s19, 0
    s_add_u32 m0, s26, 134144
    s_nop 0
    global_load_lds_dwordx4 v57, s[36:37]
    s_add_u32 s16, s16, 256
    s_addc_u32 s17, s17, 0
    s_add_u32 s18, s18, 262144
    s_addc_u32 s19, s19, 0
    s_waitcnt vmcnt(12)
    s_barrier
    s_mul_i32 s28, s32, 0
    s_add_u32 s36, s16, s28
    s_addc_u32 s37, s17, 0
    s_add_u32 m0, s25, 0
    s_nop 0
    global_load_lds_dwordx4 v52, s[36:37]
    s_mul_i32 s28, s32, 4
    s_add_u32 s36, s16, s28
    s_addc_u32 s37, s17, 0
    s_add_u32 m0, s25, 1024
    s_nop 0
    global_load_lds_dwordx4 v53, s[36:37]
    s_mul_i32 s28, s32, 8
    s_add_u32 s36, s16, s28
    s_addc_u32 s37, s17, 0
    s_add_u32 m0, s25, 2048
    s_nop 0
    global_load_lds_dwordx4 v54, s[36:37]
    s_mul_i32 s28, s32, 12
    s_add_u32 s36, s16, s28
    s_addc_u32 s37, s17, 0
    s_add_u32 m0, s25, 3072
    s_nop 0
    global_load_lds_dwordx4 v55, s[36:37]
    s_mul_i32 s28, s32, 16
    s_add_u32 s36, s16, s28
    s_addc_u32 s37, s17, 0
    s_add_u32 m0, s25, 4096
    s_nop 0
    global_load_lds_dwordx4 v52, s[36:37]
    s_mul_i32 s28, s32, 20
    s_add_u32 s36, s16, s28
    s_addc_u32 s37, s17, 0
    s_add_u32 m0, s25, 5120
    s_nop 0
    global_load_lds_dwordx4 v53, s[36:37]
    s_mul_i32 s28, s32, 24
    s_add_u32 s36, s16, s28
    s_addc_u32 s37, s17, 0
    s_add_u32 m0, s25, 6144
    s_nop 0
    global_load_lds_dwordx4 v54, s[36:37]
    s_mul_i32 s28, s32, 28
    s_add_u32 s36, s16, s28
    s_addc_u32 s37, s17, 0
    s_add_u32 m0, s25, 7168
    s_nop 0
    global_load_lds_dwordx4 v55, s[36:37]
    s_add_u32 s36, s18, 0
    s_addc_u32 s37, s19, 0
    s_add_u32 m0, s26, 32768
    s_nop 0
    global_load_lds_dwordx4 v56, s[36:37]
    s_add_u32 s36, s18, 16384
    s_addc_u32 s37, s19, 0
    s_add_u32 m0, s26, 33792
    s_nop 0
    global_load_lds_dwordx4 v57, s[36:37]
    s_add_u32 s36, s18, 32768
    s_addc_u32 s37, s19, 0
    s_add_u32 m0, s26, 34816
    s_nop 0
    global_load_lds_dwordx4 v56, s[36:37]
    s_add_u32 s36, s18, 49152
    s_addc_u32 s37, s19, 0
    s_add_u32 m0, s26, 35840
    s_nop 0
    global_load_lds_dwordx4 v57, s[36:37]
    s_add_u32 s16, s16, 256
    s_addc_u32 s17, s17, 0
    s_add_u32 s18, s18, 262144
    s_addc_u32 s19, s19, 0
    s_waitcnt vmcnt(12)
    s_barrier
    s_mul_i32 s28, s32, 0
    s_add_u32 s36, s16, s28
    s_addc_u32 s37, s17, 0
    s_add_u32 m0, s25, 49152
    s_nop 0
    global_load_lds_dwordx4 v52, s[36:37]
    s_mul_i32 s28, s32, 4
    s_add_u32 s36, s16, s28
    s_addc_u32 s37, s17, 0
    s_add_u32 m0, s25, 50176
    s_nop 0
    global_load_lds_dwordx4 v53, s[36:37]
    s_mul_i32 s28, s32, 8
    s_add_u32 s36, s16, s28
    s_addc_u32 s37, s17, 0
    s_add_u32 m0, s25, 51200
    s_nop 0
    global_load_lds_dwordx4 v54, s[36:37]
    s_mul_i32 s28, s32, 12
    s_add_u32 s36, s16, s28
    s_addc_u32 s37, s17, 0
    s_add_u32 m0, s25, 52224
    s_nop 0
    global_load_lds_dwordx4 v55, s[36:37]
    s_mul_i32 s28, s32, 16
    s_add_u32 s36, s16, s28
    s_addc_u32 s37, s17, 0
    s_add_u32 m0, s25, 53248
    s_nop 0
    global_load_lds_dwordx4 v52, s[36:37]
    s_mul_i32 s28, s32, 20
    s_add_u32 s36, s16, s28
    s_addc_u32 s37, s17, 0
    s_add_u32 m0, s25, 54272
    s_nop 0
    global_load_lds_dwordx4 v53, s[36:37]
    s_mul_i32 s28, s32, 24
    s_add_u32 s36, s16, s28
    s_addc_u32 s37, s17, 0
    s_add_u32 m0, s25, 55296
    s_nop 0
    global_load_lds_dwordx4 v54, s[36:37]
    s_mul_i32 s28, s32, 28
    s_add_u32 s36, s16, s28
    s_addc_u32 s37, s17, 0
    s_add_u32 m0, s25, 56320
    s_nop 0
    global_load_lds_dwordx4 v55, s[36:37]
    s_add_u32 s36, s18, 0
    s_addc_u32 s37, s19, 0
    s_add_u32 m0, s26, 81920
    s_nop 0
    global_load_lds_dwordx4 v56, s[36:37]
    s_add_u32 s36, s18, 16384
    s_addc_u32 s37, s19, 0
    s_add_u32 m0, s26, 82944
    s_nop 0
    global_load_lds_dwordx4 v57, s[36:37]
    s_add_u32 s36, s18, 32768
    s_addc_u32 s37, s19, 0
    s_add_u32 m0, s26, 83968
    s_nop 0
    global_load_lds_dwordx4 v56, s[36:37]
    s_add_u32 s36, s18, 49152
    s_addc_u32 s37, s19, 0
    s_add_u32 m0, s26, 84992
    s_nop 0
    global_load_lds_dwordx4 v57, s[36:37]
    s_add_u32 s16, s16, 256
    s_addc_u32 s17, s17, 0
    s_add_u32 s18, s18, 262144
    s_addc_u32 s19, s19, 0
    s_waitcnt vmcnt(12)
    s_sub_u32 s27, s27, 1
    s_cmp_lg_u32 s27, 0
    s_cbranch_scc1 L_g2_la_19
    s_mov_b32 s32, 7168
    v_or_b32 v9, 0, v3
    v_xor_b32 v9, v4, v9
    v_lshlrev_b32 v9, 4, v9
    v_mul_u32_u24 v10, 7168, v3
    v_add_u32 v52, v9, v10
    v_or_b32 v9, 4, v3
    v_xor_b32 v9, v4, v9
    v_lshlrev_b32 v9, 4, v9
    v_mul_u32_u24 v10, 7168, v3
    v_add_u32 v53, v9, v10
    v_or_b32 v9, 8, v3
    v_xor_b32 v9, v4, v9
    v_lshlrev_b32 v9, 4, v9
    v_mul_u32_u24 v10, 7168, v3
    v_add_u32 v54, v9, v10
    v_or_b32 v9, 12, v3
    v_xor_b32 v9, v4, v9
    v_lshlrev_b32 v9, 4, v9
    v_mul_u32_u24 v10, 7168, v3
    v_add_u32 v55, v9, v10
    s_lshl_b32 s28, s23, 7
    s_lshl_b32 s29, s20, 5
    s_add_u32 s28, s28, s29
    s_mul_i32 s28, s28, 7168
    s_add_u32 s28, s28, 16777216
    s_add_u32 s16, s10, s28
    s_addc_u32 s17, s11, 0
    s_lshl_b32 s28, s20, 16
    s_lshl_b32 s29, s24, 7
    s_add_u32 s28, s28, s29
    s_add_u32 s18, s6, s28
    s_addc_u32 s19, s7, 0
    s_barrier
    s_mul_i32 s28, s32, 0
    s_add_u32 s36, s16, s28
    s_addc_u32 s37, s17, 0
    s_add_u32 m0, s25, 98304
    s_nop 0
    global_load_lds_dwordx4 v52, s[36:37]
    s_mul_i32 s28, s32, 4
    s_add_u32 s36, s16, s28
    s_addc_u32 s37, s17, 0
    s_add_u32 m0, s25, 99328
    s_nop 0
    global_load_lds_dwordx4 v53, s[36:37]
    s_mul_i32 s28, s32, 8
    s_add_u32 s36, s16, s28
    s_addc_u32 s37, s17, 0
    s_add_u32 m0, s25, 100352
    s_nop 0
    global_load_lds_dwordx4 v54, s[36:37]
    s_mul_i32 s28, s32, 12
    s_add_u32 s36, s16, s28
    s_addc_u32 s37, s17, 0
    s_add_u32 m0, s25, 101376
    s_nop 0
    global_load_lds_dwordx4 v55, s[36:37]
    s_mul_i32 s28, s32, 16
    s_add_u32 s36, s16, s28
    s_addc_u32 s37, s17, 0
    s_add_u32 m0, s25, 102400
    s_nop 0
    global_load_lds_dwordx4 v52, s[36:37]
    s_mul_i32 s28, s32, 20
    s_add_u32 s36, s16, s28
    s_addc_u32 s37, s17, 0
    s_add_u32 m0, s25, 103424
    s_nop 0
    global_load_lds_dwordx4 v53, s[36:37]
    s_mul_i32 s28, s32, 24
    s_add_u32 s36, s16, s28
    s_addc_u32 s37, s17, 0
    s_add_u32 m0, s25, 104448
    s_nop 0
    global_load_lds_dwordx4 v54, s[36:37]
    s_mul_i32 s28, s32, 28
    s_add_u32 s36, s16, s28
    s_addc_u32 s37, s17, 0
    s_add_u32 m0, s25, 105472
    s_nop 0
    global_load_lds_dwordx4 v55, s[36:37]
    s_add_u32 s36, s18, 0
    s_addc_u32 s37, s19, 0
    s_add_u32 m0, s26, 131072
    s_nop 0
    global_load_lds_dwordx4 v56, s[36:37]
    s_add_u32 s36, s18, 16384
    s_addc_u32 s37, s19, 0
    s_add_u32 m0, s26, 132096
    s_nop 0
    global_load_lds_dwordx4 v57, s[36:37]
    s_add_u32 s36, s18, 32768
    s_addc_u32 s37, s19, 0
    s_add_u32 m0, s26, 133120
    s_nop 0
    global_load_lds_dwordx4 v56, s[36:37]
    s_add_u32 s36, s18, 49152
    s_addc_u32 s37, s19, 0
    s_add_u32 m0, s26, 134144
    s_nop 0
    global_load_lds_dwordx4 v57, s[36:37]
    s_add_u32 s16, s16, 256
    s_addc_u32 s17, s17, 0
    s_add_u32 s18, s18, 262144
    s_addc_u32 s19, s19, 0
    s_waitcnt vmcnt(12)
    s_barrier
    s_mul_i32 s28, s32, 0
    s_add_u32 s36, s16, s28
    s_addc_u32 s37, s17, 0
    s_add_u32 m0, s25, 0
    s_nop 0
    global_load_lds_dwordx4 v52, s[36:37]
    s_mul_i32 s28, s32, 4
    s_add_u32 s36, s16, s28
    s_addc_u32 s37, s17, 0
    s_add_u32 m0, s25, 1024
    s_nop 0
    global_load_lds_dwordx4 v53, s[36:37]
    s_mul_i32 s28, s32, 8
    s_add_u32 s36, s16, s28
    s_addc_u32 s37, s17, 0
    s_add_u32 m0, s25, 2048
    s_nop 0
    global_load_lds_dwordx4 v54, s[36:37]
    s_mul_i32 s28, s32, 12
    s_add_u32 s36, s16, s28
    s_addc_u32 s37, s17, 0
    s_add_u32 m0, s25, 3072
    s_nop 0
    global_load_lds_dwordx4 v55, s[36:37]
    s_mul_i32 s28, s32, 16
    s_add_u32 s36, s16, s28
    s_addc_u32 s37, s17, 0
    s_add_u32 m0, s25, 4096
    s_nop 0
    global_load_lds_dwordx4 v52, s[36:37]
    s_mul_i32 s28, s32, 20
    s_add_u32 s36, s16, s28
    s_addc_u32 s37, s17, 0
    s_add_u32 m0, s25, 5120
    s_nop 0
    global_load_lds_dwordx4 v53, s[36:37]
    s_mul_i32 s28, s32, 24
    s_add_u32 s36, s16, s28
    s_addc_u32 s37, s17, 0
    s_add_u32 m0, s25, 6144
    s_nop 0
    global_load_lds_dwordx4 v54, s[36:37]
    s_mul_i32 s28, s32, 28
    s_add_u32 s36, s16, s28
    s_addc_u32 s37, s17, 0
    s_add_u32 m0, s25, 7168
    s_nop 0
    global_load_lds_dwordx4 v55, s[36:37]
    s_add_u32 s36, s18, 0
    s_addc_u32 s37, s19, 0
    s_add_u32 m0, s26, 32768
    s_nop 0
    global_load_lds_dwordx4 v56, s[36:37]
    s_add_u32 s36, s18, 16384
    s_addc_u32 s37, s19, 0
    s_add_u32 m0, s26, 33792
    s_nop 0
    global_load_lds_dwordx4 v57, s[36:37]
    s_add_u32 s36, s18, 32768
    s_addc_u32 s37, s19, 0
    s_add_u32 m0, s26, 34816
    s_nop 0
    global_load_lds_dwordx4 v56, s[36:37]
    s_add_u32 s36, s18, 49152
    s_addc_u32 s37, s19, 0
    s_add_u32 m0, s26, 35840
    s_nop 0
    global_load_lds_dwordx4 v57, s[36:37]
    s_add_u32 s16, s16, 256
    s_addc_u32 s17, s17, 0
    s_add_u32 s18, s18, 262144
    s_addc_u32 s19, s19, 0
    s_waitcnt vmcnt(12)
    s_barrier
    s_mul_i32 s28, s32, 0
    s_add_u32 s36, s16, s28
    s_addc_u32 s37, s17, 0
    s_add_u32 m0, s25, 49152
    s_nop 0
    global_load_lds_dwordx4 v52, s[36:37]
    s_mul_i32 s28, s32, 4
    s_add_u32 s36, s16, s28
    s_addc_u32 s37, s17, 0
    s_add_u32 m0, s25, 50176
    s_nop 0
    global_load_lds_dwordx4 v53, s[36:37]
    s_mul_i32 s28, s32, 8
    s_add_u32 s36, s16, s28
    s_addc_u32 s37, s17, 0
    s_add_u32 m0, s25, 51200
    s_nop 0
    global_load_lds_dwordx4 v54, s[36:37]
    s_mul_i32 s28, s32, 12
    s_add_u32 s36, s16, s28
    s_addc_u32 s37, s17, 0
    s_add_u32 m0, s25, 52224
    s_nop 0
    global_load_lds_dwordx4 v55, s[36:37]
    s_mul_i32 s28, s32, 16
    s_add_u32 s36, s16, s28
    s_addc_u32 s37, s17, 0
    s_add_u32 m0, s25, 53248
    s_nop 0
    global_load_lds_dwordx4 v52, s[36:37]
    s_mul_i32 s28, s32, 20
    s_add_u32 s36, s16, s28
    s_addc_u32 s37, s17, 0
    s_add_u32 m0, s25, 54272
    s_nop 0
    global_load_lds_dwordx4 v53, s[36:37]
    s_mul_i32 s28, s32, 24
    s_add_u32 s36, s16, s28
    s_addc_u32 s37, s17, 0
    s_add_u32 m0, s25, 55296
    s_nop 0
    global_load_lds_dwordx4 v54, s[36:37]
    s_mul_i32 s28, s32, 28
    s_add_u32 s36, s16, s28
    s_addc_u32 s37, s17, 0
    s_add_u32 m0, s25, 56320
    s_nop 0
    global_load_lds_dwordx4 v55, s[36:37]
    s_add_u32 s36, s18, 0
    s_addc_u32 s37, s19, 0
    s_add_u32 m0, s26, 81920
    s_nop 0
    global_load_lds_dwordx4 v56, s[36:37]
    s_add_u32 s36, s18, 16384
    s_addc_u32 s37, s19, 0
    s_add_u32 m0, s26, 82944
    s_nop 0
    global_load_lds_dwordx4 v57, s[36:37]
    s_add_u32 s36, s18, 32768
    s_addc_u32 s37, s19, 0
    s_add_u32 m0, s26, 83968
    s_nop 0
    global_load_lds_dwordx4 v56, s[36:37]
    s_add_u32 s36, s18, 49152
    s_addc_u32 s37, s19, 0
    s_add_u32 m0, s26, 84992
    s_nop 0
    global_load_lds_dwordx4 v57, s[36:37]
    s_add_u32 s16, s16, 256
    s_addc_u32 s17, s17, 0
    s_add_u32 s18, s18, 262144
    s_addc_u32 s19, s19, 0
    s_waitcnt vmcnt(12)
    s_mov_b32 s27, 8
L_g2_lc_20:
    s_barrier
    s_mul_i32 s28, s32, 0
    s_add_u32 s36, s16, s28
    s_addc_u32 s37, s17, 0
    s_add_u32 m0, s25, 98304
    s_nop 0
    global_load_lds_dwordx4 v52, s[36:37]
    s_mul_i32 s28, s32, 4
    s_add_u32 s36, s16, s28
    s_addc_u32 s37, s17, 0
    s_add_u32 m0, s25, 99328
    s_nop 0
    global_load_lds_dwordx4 v53, s[36:37]
    s_mul_i32 s28, s32, 8
    s_add_u32 s36, s16, s28
    s_addc_u32 s37, s17, 0
    s_add_u32 m0, s25, 100352
    s_nop 0
    global_load_lds_dwordx4 v54, s[36:37]
    s_mul_i32 s28, s32, 12
    s_add_u32 s36, s16, s28
    s_addc_u32 s37, s17, 0
    s_add_u32 m0, s25, 101376
    s_nop 0
    global_load_lds_dwordx4 v55, s[36:37]
    s_mul_i32 s28, s32, 16
    s_add_u32 s36, s16, s28
    s_addc_u32 s37, s17, 0
    s_add_u32 m0, s25, 102400
    s_nop 0
    global_load_lds_dwordx4 v52, s[36:37]
    s_mul_i32 s28, s32, 20
    s_add_u32 s36, s16, s28
    s_addc_u32 s37, s17, 0
    s_add_u32 m0, s25, 103424
    s_nop 0
    global_load_lds_dwordx4 v53, s[36:37]
    s_mul_i32 s28, s32, 24
    s_add_u32 s36, s16, s28
    s_addc_u32 s37, s17, 0
    s_add_u32 m0, s25, 104448
    s_nop 0
    global_load_lds_dwordx4 v54, s[36:37]
    s_mul_i32 s28, s32, 28
    s_add_u32 s36, s16, s28
    s_addc_u32 s37, s17, 0
    s_add_u32 m0, s25, 105472
    s_nop 0
    global_load_lds_dwordx4 v55, s[36:37]
    s_add_u32 s36, s18, 0
    s_addc_u32 s37, s19, 0
    s_add_u32 m0, s26, 131072
    s_nop 0
    global_load_lds_dwordx4 v56, s[36:37]
    s_add_u32 s36, s18, 16384
    s_addc_u32 s37, s19, 0
    s_add_u32 m0, s26, 132096
    s_nop 0
    global_load_lds_dwordx4 v57, s[36:37]
    s_add_u32 s36, s18, 32768
    s_addc_u32 s37, s19, 0
    s_add_u32 m0, s26, 133120
    s_nop 0
    global_load_lds_dwordx4 v56, s[36:37]
    s_add_u32 s36, s18, 49152
    s_addc_u32 s37, s19, 0
    s_add_u32 m0, s26, 134144
    s_nop 0
    global_load_lds_dwordx4 v57, s[36:37]
    s_add_u32 s16, s16, 256
    s_addc_u32 s17, s17, 0
    s_add_u32 s18, s18, 262144
    s_addc_u32 s19, s19, 0
    s_waitcnt vmcnt(12)
    s_barrier
    s_mul_i32 s28, s32, 0
    s_add_u32 s36, s16, s28
    s_addc_u32 s37, s17, 0
    s_add_u32 m0, s25, 0
    s_nop 0
    global_load_lds_dwordx4 v52, s[36:37]
    s_mul_i32 s28, s32, 4
    s_add_u32 s36, s16, s28
    s_addc_u32 s37, s17, 0
    s_add_u32 m0, s25, 1024
    s_nop 0
    global_load_lds_dwordx4 v53, s[36:37]
    s_mul_i32 s28, s32, 8
    s_add_u32 s36, s16, s28
    s_addc_u32 s37, s17, 0
    s_add_u32 m0, s25, 2048
    s_nop 0
    global_load_lds_dwordx4 v54, s[36:37]
    s_mul_i32 s28, s32, 12
    s_add_u32 s36, s16, s28
    s_addc_u32 s37, s17, 0
    s_add_u32 m0, s25, 3072
    s_nop 0
    global_load_lds_dwordx4 v55, s[36:37]
    s_mul_i32 s28, s32, 16
    s_add_u32 s36, s16, s28
    s_addc_u32 s37, s17, 0
    s_add_u32 m0, s25, 4096
    s_nop 0
    global_load_lds_dwordx4 v52, s[36:37]
    s_mul_i32 s28, s32, 20
    s_add_u32 s36, s16, s28
    s_addc_u32 s37, s17, 0
    s_add_u32 m0, s25, 5120
    s_nop 0
    global_load_lds_dwordx4 v53, s[36:37]
    s_mul_i32 s28, s32, 24
    s_add_u32 s36, s16, s28
    s_addc_u32 s37, s17, 0
    s_add_u32 m0, s25, 6144
    s_nop 0
    global_load_lds_dwordx4 v54, s[36:37]
    s_mul_i32 s28, s32, 28
    s_add_u32 s36, s16, s28
    s_addc_u32 s37, s17, 0
    s_add_u32 m0, s25, 7168
    s_nop 0
    global_load_lds_dwordx4 v55, s[36:37]
    s_add_u32 s36, s18, 0
    s_addc_u32 s37, s19, 0
    s_add_u32 m0, s26, 32768
    s_nop 0
    global_load_lds_dwordx4 v56, s[36:37]
    s_add_u32 s36, s18, 16384
    s_addc_u32 s37, s19, 0
    s_add_u32 m0, s26, 33792
    s_nop 0
    global_load_lds_dwordx4 v57, s[36:37]
    s_add_u32 s36, s18, 32768
    s_addc_u32 s37, s19, 0
    s_add_u32 m0, s26, 34816
    s_nop 0
    global_load_lds_dwordx4 v56, s[36:37]
    s_add_u32 s36, s18, 49152
    s_addc_u32 s37, s19, 0
    s_add_u32 m0, s26, 35840
    s_nop 0
    global_load_lds_dwordx4 v57, s[36:37]
    s_add_u32 s16, s16, 256
    s_addc_u32 s17, s17, 0
    s_add_u32 s18, s18, 262144
    s_addc_u32 s19, s19, 0
    s_waitcnt vmcnt(12)
    s_barrier
    s_mul_i32 s28, s32, 0
    s_add_u32 s36, s16, s28
    s_addc_u32 s37, s17, 0
    s_add_u32 m0, s25, 49152
    s_nop 0
    global_load_lds_dwordx4 v52, s[36:37]
    s_mul_i32 s28, s32, 4
    s_add_u32 s36, s16, s28
    s_addc_u32 s37, s17, 0
    s_add_u32 m0, s25, 50176
    s_nop 0
    global_load_lds_dwordx4 v53, s[36:37]
    s_mul_i32 s28, s32, 8
    s_add_u32 s36, s16, s28
    s_addc_u32 s37, s17, 0
    s_add_u32 m0, s25, 51200
    s_nop 0
    global_load_lds_dwordx4 v54, s[36:37]
    s_mul_i32 s28, s32, 12
    s_add_u32 s36, s16, s28
    s_addc_u32 s37, s17, 0
    s_add_u32 m0, s25, 52224
    s_nop 0
    global_load_lds_dwordx4 v55, s[36:37]
    s_mul_i32 s28, s32, 16
    s_add_u32 s36, s16, s28
    s_addc_u32 s37, s17, 0
    s_add_u32 m0, s25, 53248
    s_nop 0
    global_load_lds_dwordx4 v52, s[36:37]
    s_mul_i32 s28, s32, 20
    s_add_u32 s36, s16, s28
    s_addc_u32 s37, s17, 0
    s_add_u32 m0, s25, 54272
    s_nop 0
    global_load_lds_dwordx4 v53, s[36:37]
    s_mul_i32 s28, s32, 24
    s_add_u32 s36, s16, s28
    s_addc_u32 s37, s17, 0
    s_add_u32 m0, s25, 55296
    s_nop 0
    global_load_lds_dwordx4 v54, s[36:37]
    s_mul_i32 s28, s32, 28
    s_add_u32 s36, s16, s28
    s_addc_u32 s37, s17, 0
    s_add_u32 m0, s25, 56320
    s_nop 0
    global_load_lds_dwordx4 v55, s[36:37]
    s_add_u32 s36, s18, 0
    s_addc_u32 s37, s19, 0
    s_add_u32 m0, s26, 81920
    s_nop 0
    global_load_lds_dwordx4 v56, s[36:37]
    s_add_u32 s36, s18, 16384
    s_addc_u32 s37, s19, 0
    s_add_u32 m0, s26, 82944
    s_nop 0
    global_load_lds_dwordx4 v57, s[36:37]
    s_add_u32 s36, s18, 32768
    s_addc_u32 s37, s19, 0
    s_add_u32 m0, s26, 83968
    s_nop 0
    global_load_lds_dwordx4 v56, s[36:37]
    s_add_u32 s36, s18, 49152
    s_addc_u32 s37, s19, 0
    s_add_u32 m0, s26, 84992
    s_nop 0
    global_load_lds_dwordx4 v57, s[36:37]
    s_add_u32 s16, s16, 256
    s_addc_u32 s17, s17, 0
    s_add_u32 s18, s18, 262144
    s_addc_u32 s19, s19, 0
    s_waitcnt vmcnt(12)
    s_sub_u32 s27, s27, 1
    s_cmp_lg_u32 s27, 0
    s_cbranch_scc1 L_g2_lc_20
    s_barrier
    s_mul_i32 s28, s32, 0
    s_add_u32 s36, s16, s28
    s_addc_u32 s37, s17, 0
    s_add_u32 m0, s25, 98304
    s_nop 0
    global_load_lds_dwordx4 v52, s[36:37]
    s_mul_i32 s28, s32, 4
    s_add_u32 s36, s16, s28
    s_addc_u32 s37, s17, 0
    s_add_u32 m0, s25, 99328
    s_nop 0
    global_load_lds_dwordx4 v53, s[36:37]
    s_mul_i32 s28, s32, 8
    s_add_u32 s36, s16, s28
    s_addc_u32 s37, s17, 0
    s_add_u32 m0, s25, 100352
    s_nop 0
    global_load_lds_dwordx4 v54, s[36:37]
    s_mul_i32 s28, s32, 12
    s_add_u32 s36, s16, s28
    s_addc_u32 s37, s17, 0
    s_add_u32 m0, s25, 101376
    s_nop 0
    global_load_lds_dwordx4 v55, s[36:37]
    s_mul_i32 s28, s32, 16
    s_add_u32 s36, s16, s28
    s_addc_u32 s37, s17, 0
    s_add_u32 m0, s25, 102400
    s_nop 0
    global_load_lds_dwordx4 v52, s[36:37]
    s_mul_i32 s28, s32, 20
    s_add_u32 s36, s16, s28
    s_addc_u32 s37, s17, 0
    s_add_u32 m0, s25, 103424
    s_nop 0
    global_load_lds_dwordx4 v53, s[36:37]
    s_mul_i32 s28, s32, 24
    s_add_u32 s36, s16, s28
    s_addc_u32 s37, s17, 0
    s_add_u32 m0, s25, 104448
    s_nop 0
    global_load_lds_dwordx4 v54, s[36:37]
    s_mul_i32 s28, s32, 28
    s_add_u32 s36, s16, s28
    s_addc_u32 s37, s17, 0
    s_add_u32 m0, s25, 105472
    s_nop 0
    global_load_lds_dwordx4 v55, s[36:37]
    s_add_u32 s36, s18, 0
    s_addc_u32 s37, s19, 0
    s_add_u32 m0, s26, 131072
    s_nop 0
    global_load_lds_dwordx4 v56, s[36:37]
    s_add_u32 s36, s18, 16384
    s_addc_u32 s37, s19, 0
    s_add_u32 m0, s26, 132096
    s_nop 0
    global_load_lds_dwordx4 v57, s[36:37]
    s_add_u32 s36, s18, 32768
    s_addc_u32 s37, s19, 0
    s_add_u32 m0, s26, 133120
    s_nop 0
    global_load_lds_dwordx4 v56, s[36:37]
    s_add_u32 s36, s18, 49152
    s_addc_u32 s37, s19, 0
    s_add_u32 m0, s26, 134144
    s_nop 0
    global_load_lds_dwordx4 v57, s[36:37]
    s_add_u32 s16, s16, 256
    s_addc_u32 s17, s17, 0
    s_add_u32 s18, s18, 262144
    s_addc_u32 s19, s19, 0
    s_waitcnt vmcnt(12)
    s_barrier
    s_waitcnt vmcnt(0)
    s_barrier
    s_waitcnt vmcnt(0)
L_g2_early_15:
    s_endpgm
.section .rodata,"a"
.p2align 6
.amdhsa_kernel ln_kernel
  .amdhsa_next_free_vgpr 40
  .amdhsa_next_free_sgpr 16
  .amdhsa_accum_offset 40
  .amdhsa_group_segment_fixed_size 0
  .amdhsa_kernarg_size 80
  .amdhsa_user_sgpr_count 2
  .amdhsa_user_sgpr_kernarg_segment_ptr 1
  .amdhsa_system_sgpr_workgroup_id_x 1
.end_amdhsa_kernel
.p2align 6
.amdhsa_kernel gemm1_kernel
  .amdhsa_next_free_vgpr 256
  .amdhsa_next_free_sgpr 96
  .amdhsa_accum_offset 256
  .amdhsa_group_segment_fixed_size 0
  .amdhsa_kernarg_size 80
  .amdhsa_user_sgpr_count 2
  .amdhsa_user_sgpr_kernarg_segment_ptr 1
  .amdhsa_system_sgpr_workgroup_id_x 1
.end_amdhsa_kernel
.p2align 6
.amdhsa_kernel att_kernel
  .amdhsa_next_free_vgpr 108
  .amdhsa_next_free_sgpr 64
  .amdhsa_accum_offset 108
  .amdhsa_group_segment_fixed_size 0
  .amdhsa_kernarg_size 80
  .amdhsa_user_sgpr_count 2
  .amdhsa_user_sgpr_kernarg_segment_ptr 1
  .amdhsa_system_sgpr_workgroup_id_x 1
.end_amdhsa_kernel
.p2align 6
.amdhsa_kernel gemm2_kernel
  .amdhsa_next_free_vgpr 128
  .amdhsa_next_free_sgpr 80
  .amdhsa_accum_offset 128
  .amdhsa_group_segment_fixed_size 0
  .amdhsa_kernarg_size 80
  .amdhsa_user_sgpr_count 2
  .amdhsa_user_sgpr_kernarg_segment_ptr 1
  .amdhsa_system_sgpr_workgroup_id_x 1
.end_amdhsa_kernel
```
